```python
import torch

def _softmax(x, axis=-1):
    return torch.softmax(x, dim=axis)
def _gelu(x):
    return torch.nn.functional.gelu(x, approximate="tanh")
def _silu(x):
    return torch.nn.functional.silu(x)
def _sigmoid(x):
    return torch.sigmoid(x)
def _layernorm(x, axis=-1, eps=1e-5):
    m = x.mean(dim=axis, keepdim=True)
    v = x.var(dim=axis, keepdim=True, unbiased=False)
    return (x - m) / torch.sqrt(v + eps)
def _scatter_add(tgt, idx, src, axis=0):
    return tgt.clone().index_add_(axis, idx, src)
def _segment_sum(src, seg, n):
    out = torch.zeros((n,) + src.shape[1:], dtype=src.dtype)
    return out.index_add_(0, seg, src)
def _pad(x, pw):
    flat = tuple(v for pair in reversed(pw) for v in pair)
    return torch.nn.functional.pad(x, flat)

kernel_name = 'concat_heads__ssm_conv_s4d__linear_kernel_hedgehog__prompt'

def setup_inputs():

    _w = (lambda a: (lambda t: t.to(torch.bfloat16) if t.is_floating_point() else t)(torch.as_tensor(a)))
    def _A_setup():
        Bsz, L, D, N = 1, 2048, 640, 128
        return {
            "u": _w((lambda *s: torch.randn(*s, dtype=torch.bfloat16) * 0.05)(Bsz, L, D)),
            "log_A_real": _w((lambda *s: torch.randn(*s, dtype=torch.bfloat16) * 3.2)(D, N) * 0.5),
            "A_imag": _w((lambda *s: torch.randn(*s, dtype=torch.bfloat16) * 0.1)(D, N) * 3.14),
            "C_real": _w((lambda *s: torch.randn(*s, dtype=torch.bfloat16) * 1.6)(D, N) / N ** 0.5),
            "C_imag": _w((lambda *s: torch.randn(*s, dtype=torch.bfloat16) * 1.6)(D, N) / N ** 0.5),
            "log_dt": _w((lambda *s: torch.randn(*s, dtype=torch.bfloat16) * 0.1)(D) * 0.5 - 4.0),
            "D_skip": _w((lambda *s: torch.randn(*s, dtype=torch.bfloat16) * 0.1)(D)),
        }
    _A_in = _A_setup()

    def _B_setup():
        B, S, D, H = 1, 2048, 640, 32
        Dh = D // H
        return {
            "x": _w((lambda *s: torch.randn(*s, dtype=torch.bfloat16) * 0.4)(B, S, D)),
            "wqkv": _w((lambda *s: torch.randn(*s, dtype=torch.bfloat16) * 0.4)(D, 3 * D)),
            "w_phi": _w((lambda *s: torch.randn(*s, dtype=torch.bfloat16) * 0.4)(H, Dh, Dh) * (Dh ** -0.5)),
            "wo": _w((lambda *s: torch.randn(*s, dtype=torch.bfloat16) * 0.05)(D, D)),
        }
    _B_in = _B_setup()

    return {
        "A_u": _A_in["u"],
        "A_log_A_real": _A_in["log_A_real"],
        "A_A_imag": _A_in["A_imag"],
        "A_C_real": _A_in["C_real"],
        "A_C_imag": _A_in["C_imag"],
        "A_log_dt": _A_in["log_dt"],
        "A_D_skip": _A_in["D_skip"],
        "B_x": _B_in["x"],
        "B_wqkv": _B_in["wqkv"],
        "B_w_phi": _B_in["w_phi"],
        "B_wo": _B_in["wo"],
    }

def reference(A_u, A_log_A_real, A_A_imag, A_C_real, A_C_imag, A_log_dt, A_D_skip, B_x, B_wqkv, B_w_phi, B_wo):
    def _A_ref(u, log_A_real, A_imag, C_real, C_imag, log_dt, D_skip):
        L = u.shape[1]
        dt = torch.exp(log_dt)
        A = -torch.exp(log_A_real) + 1j * A_imag
        C = (C_real + 1j * C_imag) * dt[:, None]
        pos = (lambda x, dt: x.to(dt))(torch.arange(L), log_dt.dtype)
        P = torch.exp((A * dt[:, None])[:, :, None] * pos[None, None, :])
        K = 2.0 * torch.einsum("dn,dnl->dl", C, P).real
        L2 = 2 * L
        u_t = (lambda x, *d: x.permute(*d))(u, 0, 2, 1)
        Kf = (lambda x, *a, **k: torch.fft.rfft(x.float(), *a, **k))(K, L2)
        Uf = (lambda x, *a, **k: torch.fft.rfft(x.float(), *a, **k))(u_t, L2)
        y = (lambda x, *a, **k: torch.fft.irfft(x, *a, **k).to(torch.bfloat16))(Uf * Kf[None, :, :], L2)[:, :, :L]
        y = (lambda x, *d: x.permute(*d))(y, 0, 2, 1)
        return y + u * D_skip[None, None, :]

    def _B_ref(x, wqkv, w_phi, wo):
        B, S, D = x.shape
        H = 32; Dh = D // H
        qkv = (lambda x, *d: x.permute(*d))((x @ wqkv).reshape(B, S, 3, H, Dh), 2, 0, 3, 1, 4)
        q, k, v = qkv[0], qkv[1], qkv[2]
        pq = torch.einsum("bhsd,hdf->bhsf", q, w_phi)
        pk = torch.einsum("bhsd,hdf->bhsf", k, w_phi)
        phi_q = torch.concatenate([_softmax(pq, axis=-1), _softmax(-pq, axis=-1)], axis=-1)
        phi_k = torch.concatenate([_softmax(pk, axis=-1), _softmax(-pk, axis=-1)], axis=-1)
        kv = torch.einsum("bhsf,bhsd->bhfd", phi_k, v)
        z  = torch.einsum("bhsf->bhf", phi_k)
        num = torch.einsum("bhqf,bhfd->bhqd", phi_q, kv)
        den = torch.einsum("bhqf,bhf->bhq", phi_q, z)[..., None] + 1e-6
        o = num / den
        return (lambda x, *d: x.permute(*d))(o, 0, 2, 1, 3).reshape(B, S, D) @ wo

    a = _A_ref(A_u, A_log_A_real, A_A_imag, A_C_real, A_C_imag, A_log_dt, A_D_skip)
    b = _B_ref(B_x, B_wqkv, B_w_phi, B_wo)
    return torch.concatenate([a, b], axis=-1)
```

```asm
; @launch grid=(504,1,1) block=(256,1,1) lds=81920
.amdgcn_target "amdgcn-amd-amdhsa--gfx950"
.text
.globl concat_heads__ssm_conv_s4d__linear_kernel_hedgehog__prompt_kernel
.p2align 8
.type concat_heads__ssm_conv_s4d__linear_kernel_hedgehog__prompt_kernel,@function
concat_heads__ssm_conv_s4d__linear_kernel_hedgehog__prompt_kernel:
    s_cmp_ge_u32 s2, 504
    s_cbranch_scc1 L_end
    s_cmp_ge_u32 s2, 256
    s_cbranch_scc1 L_roleA
    s_load_dwordx2 s[8:9], s[0:1], 56
    s_load_dwordx2 s[12:13], s[0:1], 64
    s_load_dwordx2 s[20:21], s[0:1], 72
    s_load_dwordx2 s[16:17], s[0:1], 104
    s_setprio 2
    v_lshrrev_b32 v21, 6, v0
    v_and_b32 v1, 63, v0
    v_readfirstlane_b32 s3, v21
    v_and_b32 v2, 15, v1
    v_lshrrev_b32 v3, 4, v1
    s_and_b32 s50, s2, 7
    s_lshr_b32 s51, s2, 3
    s_lshr_b32 s4, s50, 1
    s_lshl_b32 s4, s4, 2
    s_and_b32 s52, s51, 3
    s_add_u32 s4, s4, s52
    s_and_b32 s5, s50, 1
    s_lshl_b32 s5, s5, 3
    s_lshr_b32 s52, s51, 2
    s_add_u32 s5, s5, s52
    s_add_u32 s52, s4, s5
    s_mul_i32 s53, s52, 26
    s_lshr_b32 s53, s53, 8
    s_mul_i32 s53, s53, 10
    s_sub_u32 s6, s52, s53
    s_lshl_b32 s52, s4, 7
    s_lshl_b32 s53, s3, 5
    s_add_u32 s52, s52, s53
    s_mul_i32 s32, s52, 1280
    s_mul_i32 s55, s5, 80
    s_mul_i32 s54, s3, 61440
    s_add_u32 s33, s54, s55
    s_add_u32 s33, s33, 1280
    s_lshl_b32 s36, s3, 13
    s_add_u32 s36, s36, 43520
    s_mul_i32 s37, s3, 2560
    s_mov_b32 s38, s37
    s_add_u32 s37, s37, 2560
    s_mov_b32 s34, s6
    s_mov_b32 s35, s6
    s_and_b32 s54, s3, 1
    s_mul_i32 s54, s54, 122880
    s_add_u32 s39, s54, s55
    v_lshrrev_b32 v21, 3, v1
    v_mul_u32_u24 v21, 1280, v21
    v_and_b32 v22, 7, v1
    v_xor_b32 v22, v22, v3
    v_lshl_add_u32 v4, v22, 4, v21
    v_xor_b32 v22, 4, v22
    v_lshl_add_u32 v5, v22, 4, v21
    s_waitcnt lgkmcnt(0)
    s_load_dword s25, s[16:17], 0
    s_mov_b32 s10, 2621440
    s_mov_b32 s11, 0x20000
    s_mov_b32 s14, 2457600
    s_mov_b32 s15, 0x20000
    s_mov_b32 s60, s16
    s_mov_b32 s61, s17
    s_mov_b32 s62, 268435456
    s_mov_b32 s63, 0x20000
    s_lshl_b32 s56, s34, 7
    s_add_u32 s56, s56, s32
    s_add_u32 s34, s34, 1
    s_cmp_eq_u32 s34, 10
    s_cselect_b32 s34, 0, s34
    s_add_u32 m0, s36, 0
    s_nop 0
    buffer_load_dwordx4 v4, s[8:11], s56 offen lds
    s_add_u32 s56, s56, 10240
    s_add_u32 m0, s36, 1024
    s_nop 0
    buffer_load_dwordx4 v5, s[8:11], s56 offen lds
    s_add_u32 s56, s56, 10240
    s_add_u32 m0, s36, 2048
    s_nop 0
    buffer_load_dwordx4 v4, s[8:11], s56 offen lds
    s_add_u32 s56, s56, 10240
    s_add_u32 m0, s36, 3072
    s_nop 0
    buffer_load_dwordx4 v5, s[8:11], s56 offen lds
    s_lshl_b32 s56, s34, 7
    s_add_u32 s56, s56, s32
    s_add_u32 s34, s34, 1
    s_cmp_eq_u32 s34, 10
    s_cselect_b32 s34, 0, s34
    s_add_u32 m0, s36, 4096
    s_nop 0
    buffer_load_dwordx4 v4, s[8:11], s56 offen lds
    s_add_u32 s56, s56, 10240
    s_add_u32 m0, s36, 5120
    s_nop 0
    buffer_load_dwordx4 v5, s[8:11], s56 offen lds
    s_add_u32 s56, s56, 10240
    s_add_u32 m0, s36, 6144
    s_nop 0
    buffer_load_dwordx4 v4, s[8:11], s56 offen lds
    s_add_u32 s56, s56, 10240
    s_add_u32 m0, s36, 7168
    s_nop 0
    buffer_load_dwordx4 v5, s[8:11], s56 offen lds
    v_add_u32 v21, 0, v1
    v_mul_u32_u24 v22, 205, v21
    v_lshrrev_b32 v22, 11, v22
    v_mul_u32_u24 v23, 10, v22
    v_sub_u32 v21, v21, v23
    v_cmp_eq_u32 vcc, 4, v21
    v_cmp_eq_u32 s[58:59], 9, v21
    v_xor_b32 v23, 13, v21
    s_or_b64 vcc, vcc, s[58:59]
    s_nop 1
    v_cndmask_b32 v21, v21, v23, vcc
    v_and_b32 v23, 3, v22
    v_and_b32 v8, 4, v22
    v_lshl_or_b32 v23, v8, 1, v23
    v_and_b32 v8, 8, v22
    v_lshrrev_b32 v8, 1, v8
    v_or_b32 v23, v23, v8
    v_mul_u32_u24 v23, 3840, v23
    v_lshl_add_u32 v23, v21, 4, v23
    v_cmp_lt_u32 vcc, 4, v21
    v_add_u32 v22, 1200, v23
    s_nop 0
    v_cndmask_b32 v8, v23, v22, vcc
    v_add_u32 v21, 64, v1
    v_mul_u32_u24 v22, 205, v21
    v_lshrrev_b32 v22, 11, v22
    v_mul_u32_u24 v23, 10, v22
    v_sub_u32 v21, v21, v23
    v_cmp_eq_u32 vcc, 4, v21
    v_cmp_eq_u32 s[58:59], 9, v21
    v_xor_b32 v23, 13, v21
    s_or_b64 vcc, vcc, s[58:59]
    s_nop 1
    v_cndmask_b32 v21, v21, v23, vcc
    v_and_b32 v23, 3, v22
    v_and_b32 v9, 4, v22
    v_lshl_or_b32 v23, v9, 1, v23
    v_and_b32 v9, 8, v22
    v_lshrrev_b32 v9, 1, v9
    v_or_b32 v23, v23, v9
    v_mul_u32_u24 v23, 3840, v23
    v_lshl_add_u32 v23, v21, 4, v23
    v_cmp_lt_u32 vcc, 4, v21
    v_add_u32 v22, 1200, v23
    s_nop 0
    v_cndmask_b32 v9, v23, v22, vcc
    v_add_u32 v21, 128, v1
    v_min_u32 v21, 159, v21
    v_mul_u32_u24 v22, 205, v21
    v_lshrrev_b32 v22, 11, v22
    v_mul_u32_u24 v23, 10, v22
    v_sub_u32 v21, v21, v23
    v_cmp_eq_u32 vcc, 4, v21
    v_cmp_eq_u32 s[58:59], 9, v21
    v_xor_b32 v23, 13, v21
    s_or_b64 vcc, vcc, s[58:59]
    s_nop 1
    v_cndmask_b32 v21, v21, v23, vcc
    v_and_b32 v23, 3, v22
    v_and_b32 v10, 4, v22
    v_lshl_or_b32 v23, v10, 1, v23
    v_and_b32 v10, 8, v22
    v_lshrrev_b32 v10, 1, v10
    v_or_b32 v23, v23, v10
    v_mul_u32_u24 v23, 3840, v23
    v_lshl_add_u32 v23, v21, 4, v23
    v_cmp_lt_u32 vcc, 4, v21
    v_add_u32 v22, 1200, v23
    s_nop 0
    v_cndmask_b32 v10, v23, v22, vcc
    s_mul_i32 s57, s35, 245760
    s_add_u32 s57, s57, s33
    s_add_u32 s35, s35, 1
    s_cmp_eq_u32 s35, 10
    s_cselect_b32 s35, 0, s35
    s_add_u32 m0, s37, 0
    s_nop 0
    buffer_load_dwordx4 v8, s[12:15], s57 offen lds
    s_add_u32 m0, s37, 1024
    s_nop 0
    buffer_load_dwordx4 v9, s[12:15], s57 offen lds
    s_mov_b32 exec_hi, 0
    s_add_u32 m0, s37, 2048
    s_nop 0
    buffer_load_dwordx4 v10, s[12:15], s57 offen lds
    s_mov_b32 exec_hi, -1
    s_mul_i32 s57, s35, 245760
    s_add_u32 s57, s57, s33
    s_add_u32 s35, s35, 1
    s_cmp_eq_u32 s35, 10
    s_cselect_b32 s35, 0, s35
    s_add_u32 m0, s37, 10240
    s_nop 0
    buffer_load_dwordx4 v8, s[12:15], s57 offen lds
    s_add_u32 m0, s37, 11264
    s_nop 0
    buffer_load_dwordx4 v9, s[12:15], s57 offen lds
    s_mov_b32 exec_hi, 0
    s_add_u32 m0, s37, 12288
    s_nop 0
    buffer_load_dwordx4 v10, s[12:15], s57 offen lds
    s_mov_b32 exec_hi, -1
    s_mul_i32 s55, s5, 1600
    v_lshlrev_b32 v21, 2, v0
    v_add_u32 v21, s55, v21
    v_min_u32 v22, 143, v0
    v_lshlrev_b32 v22, 2, v22
    v_add_u32 v22, s55, v22
    global_load_dword v24, v21, s[20:21]
    global_load_dword v25, v22, s[20:21] offset:1024
    s_mul_i32 s57, s35, 245760
    s_add_u32 s57, s57, s33
    s_add_u32 s35, s35, 1
    s_cmp_eq_u32 s35, 10
    s_cselect_b32 s35, 0, s35
    s_add_u32 m0, s37, 20480
    s_nop 0
    buffer_load_dwordx4 v8, s[12:15], s57 offen lds
    s_add_u32 m0, s37, 21504
    s_nop 0
    buffer_load_dwordx4 v9, s[12:15], s57 offen lds
    s_mov_b32 exec_hi, 0
    s_add_u32 m0, s37, 22528
    s_nop 0
    buffer_load_dwordx4 v10, s[12:15], s57 offen lds
    s_mov_b32 exec_hi, -1
    v_mov_b32 v64, 0
    v_mov_b32 v65, 0
    v_mov_b32 v66, 0
    v_mov_b32 v67, 0
    v_lshlrev_b32 v21, 4, v0
    v_cmp_gt_u32 vcc, 160, v0
    s_nop 0
    s_and_saveexec_b64 s[58:59], vcc
    ds_write_b128 v21, v[64:67]
    s_mov_b64 exec, s[58:59]
    v_add_u32 v21, 76288, v21
    ds_write_b128 v21, v[64:67]
    v_cmp_gt_u32 vcc, 96, v0
    s_nop 0
    s_and_saveexec_b64 s[58:59], vcc
    ds_write_b128 v21, v[64:67] offset:4096
    s_mov_b64 exec, s[58:59]
    v_bfe_u32 v21, v2, 1, 3
    v_xor_b32 v21, v21, v3
    v_lshlrev_b32 v21, 4, v21
    v_lshl_add_u32 v21, v2, 7, v21
    v_add_u32 v6, s36, v21
    v_xor_b32 v21, 64, v21
    v_add_u32 v7, s36, v21
    v_lshrrev_b32 v21, 2, v2
    v_and_b32 v22, 3, v1
    v_lshlrev_b32 v22, 3, v22
    v_lshrrev_b32 v23, 1, v3
    v_lshlrev_b32 v23, 4, v23
    v_and_b32 v11, 1, v3
    v_lshl_add_u32 v23, v11, 2, v23
    v_add_u32 v23, v23, v21
    v_mul_u32_u24 v23, 160, v23
    v_add_u32 v23, 2560, v23
    s_mov_b32 s55, 302318336
    v_bfe_u32 v11, s55, v22, 8
    v_lshl_add_u32 v11, v11, 3, v23
    s_mov_b32 s55, 285674498
    v_bfe_u32 v12, s55, v22, 8
    v_lshl_add_u32 v12, v12, 3, v23
    s_mov_b32 s55, 135204106
    v_bfe_u32 v13, s55, v22, 8
    v_lshl_add_u32 v13, v13, 3, v23
    v_and_b32 v23, 1, v3
    v_lshl_add_u32 v23, v23, 2, v21
    v_lshlrev_b32 v23, 1, v23
    v_lshrrev_b32 v17, 1, v3
    v_lshl_add_u32 v23, v17, 4, v23
    v_mul_u32_u24 v23, 80, v23
    v_add_u32 v23, 33280, v23
    s_mov_b32 s55, 34014464
    v_bfe_u32 v17, s55, v22, 8
    v_lshl_add_u32 v17, v17, 3, v23
    s_mov_b32 s55, 151585796
    v_bfe_u32 v18, s55, v22, 8
    v_lshl_add_u32 v18, v18, 3, v23
    v_and_b32 v22, 3, v1
    v_lshrrev_b32 v23, 1, v22
    v_lshrrev_b32 v28, 1, v3
    v_cmp_eq_u32 s[58:59], v23, v28
    v_mul_u32_u24 v28, 960, v28
    v_and_b32 v22, 1, v22
    v_lshl_add_u32 v28, v22, 3, v28
    v_and_b32 v22, 1, v3
    v_mul_u32_u24 v23, 12, v22
    v_add_u32 v23, v23, v21
    v_mul_u32_u24 v23, 48, v23
    v_add_u32 v23, v23, v28
    v_add_u32 v23, 0, v23
    v_mov_b32 v19, 1920
    v_cndmask_b32 v19, v19, v23, s[58:59]
    v_cmp_eq_u32 vcc, 0, v22
    v_add_u32 v23, 8, v21
    s_and_b64 s[58:59], s[58:59], vcc
    v_mul_u32_u24 v23, 48, v23
    v_add_u32 v23, v23, v28
    v_add_u32 v23, 0, v23
    v_mov_b32 v20, 1920
    v_cndmask_b32 v20, v20, v23, s[58:59]
    v_mov_b32 v21, v0
    v_cmp_le_u32 vcc, 200, v21
    v_subrev_u32 v22, 200, v21
    s_nop 0
    v_cndmask_b32 v21, v21, v22, vcc
    v_mov_b32 v22, 0
    v_mov_b32 v23, 960
    v_cndmask_b32 v26, v22, v23, vcc
    v_mul_u32_u24 v22, 205, v21
    v_lshrrev_b32 v22, 11, v22
    v_mul_u32_u24 v23, 10, v22
    v_sub_u32 v21, v21, v23
    v_mul_u32_u24 v22, 48, v22
    v_add_u32 v26, v26, v22
    v_cmp_le_u32 vcc, 5, v21
    v_subrev_u32 v22, 5, v21
    s_nop 0
    v_cndmask_b32 v21, v21, v22, vcc
    v_mov_b32 v22, 0
    v_mov_b32 v23, 8
    v_cndmask_b32 v22, v22, v23, vcc
    v_add_u32 v26, v26, v22
    v_lshrrev_b32 v22, 1, v21
    v_lshl_add_u32 v26, v22, 4, v26
    v_and_b32 v22, 1, v21
    v_lshl_add_u32 v26, v22, 2, v26
    v_min_u32 v21, 143, v0
    v_add_u32 v21, 256, v21
    v_cmp_le_u32 vcc, 200, v21
    v_subrev_u32 v22, 200, v21
    s_nop 0
    v_cndmask_b32 v21, v21, v22, vcc
    v_mov_b32 v22, 0
    v_mov_b32 v23, 960
    v_cndmask_b32 v27, v22, v23, vcc
    v_mul_u32_u24 v22, 205, v21
    v_lshrrev_b32 v22, 11, v22
    v_mul_u32_u24 v23, 10, v22
    v_sub_u32 v21, v21, v23
    v_mul_u32_u24 v22, 48, v22
    v_add_u32 v27, v27, v22
    v_cmp_le_u32 vcc, 5, v21
    v_subrev_u32 v22, 5, v21
    s_nop 0
    v_cndmask_b32 v21, v21, v22, vcc
    v_mov_b32 v22, 0
    v_mov_b32 v23, 8
    v_cndmask_b32 v22, v22, v23, vcc
    v_add_u32 v27, v27, v22
    v_lshrrev_b32 v22, 1, v21
    v_lshl_add_u32 v27, v22, 4, v27
    v_and_b32 v22, 1, v21
    v_lshl_add_u32 v27, v22, 2, v27
    v_add_u32 v21, 0, v1
    v_min_u32 v21, 159, v21
    v_mul_u32_u24 v22, 205, v21
    v_lshrrev_b32 v22, 10, v22
    v_mul_u32_u24 v23, 5, v22
    v_sub_u32 v21, v21, v23
    v_add_u32 v23, -1, v21
    v_cmp_eq_u32 vcc, 1, v21
    v_mov_b32 v14, 4
    s_nop 0
    v_cndmask_b32 v23, v23, v14, vcc
    v_cmp_eq_u32 vcc, 0, v21
    v_and_b32 v14, 1, v22
    s_nop 0
    v_cndmask_b32 v21, v23, v21, vcc
    v_and_b32 v23, 24, v22
    v_lshl_or_b32 v23, v14, 2, v23
    v_bfe_u32 v22, v22, 1, 2
    v_or_b32 v23, v23, v22
    v_mul_u32_u24 v23, 3840, v23
    v_lshl_add_u32 v14, v21, 4, v23
    v_add_u32 v21, 64, v1
    v_min_u32 v21, 159, v21
    v_mul_u32_u24 v22, 205, v21
    v_lshrrev_b32 v22, 10, v22
    v_mul_u32_u24 v23, 5, v22
    v_sub_u32 v21, v21, v23
    v_add_u32 v23, -1, v21
    v_cmp_eq_u32 vcc, 1, v21
    v_mov_b32 v15, 4
    s_nop 0
    v_cndmask_b32 v23, v23, v15, vcc
    v_cmp_eq_u32 vcc, 0, v21
    v_and_b32 v15, 1, v22
    s_nop 0
    v_cndmask_b32 v21, v23, v21, vcc
    v_and_b32 v23, 24, v22
    v_lshl_or_b32 v23, v15, 2, v23
    v_bfe_u32 v22, v22, 1, 2
    v_or_b32 v23, v23, v22
    v_mul_u32_u24 v23, 3840, v23
    v_lshl_add_u32 v15, v21, 4, v23
    v_add_u32 v21, 128, v1
    v_min_u32 v21, 159, v21
    v_mul_u32_u24 v22, 205, v21
    v_lshrrev_b32 v22, 10, v22
    v_mul_u32_u24 v23, 5, v22
    v_sub_u32 v21, v21, v23
    v_add_u32 v23, -1, v21
    v_cmp_eq_u32 vcc, 1, v21
    v_mov_b32 v16, 4
    s_nop 0
    v_cndmask_b32 v23, v23, v16, vcc
    v_cmp_eq_u32 vcc, 0, v21
    v_and_b32 v16, 1, v22
    s_nop 0
    v_cndmask_b32 v21, v23, v21, vcc
    v_and_b32 v23, 24, v22
    v_lshl_or_b32 v23, v16, 2, v23
    v_bfe_u32 v22, v22, 1, 2
    v_or_b32 v23, v23, v22
    v_mul_u32_u24 v23, 3840, v23
    v_lshl_add_u32 v16, v21, 4, v23
    s_waitcnt lgkmcnt(0)
    s_mul_i32 s24, s25, 0x9E3779B1
    s_add_u32 s24, s24, 0x7F4A7C15
    s_mov_b32 s22, 0x3fb8aa3b
    s_mov_b32 s23, 0x3fb8aa3b
    s_lshr_b32 s40, s3, 1
    s_add_u32 s40, s40, s6
    s_waitcnt vmcnt(3)
    s_barrier
    ds_write_b32 v26, v24 offset:0
    v_cmp_gt_u32 vcc, 144, v0
    s_nop 0
    s_and_saveexec_b64 s[58:59], vcc
    ds_write_b32 v27, v25 offset:0
    s_mov_b64 exec, s[58:59]
    ds_read_b128 v[96:99], v6 offset:0
    ds_read_b128 v[100:103], v6 offset:2048
    ds_read_b128 v[104:107], v7 offset:0
    ds_read_b128 v[108:111], v7 offset:2048
    ds_read_b128 v[112:115], v6 offset:4096
    ds_read_b128 v[116:119], v6 offset:6144
    ds_read_b128 v[120:123], v7 offset:4096
    ds_read_b128 v[124:127], v7 offset:6144
    ds_read_b64_tr_b16 v[64:65], v11 offset:0
    ds_read_b64_tr_b16 v[66:67], v11 offset:1280
    ds_read_b64_tr_b16 v[68:69], v11 offset:8
    ds_read_b64_tr_b16 v[70:71], v11 offset:1288
    ds_read_b64_tr_b16 v[72:73], v12 offset:0
    ds_read_b64_tr_b16 v[74:75], v12 offset:1280
    ds_read_b64_tr_b16 v[76:77], v13 offset:0
    ds_read_b64_tr_b16 v[78:79], v13 offset:1280
    ds_read_b64_tr_b16 v[80:81], v13 offset:8
    ds_read_b64_tr_b16 v[82:83], v13 offset:1288
    ds_read_b64_tr_b16 v[84:85], v11 offset:5120
    ds_read_b64_tr_b16 v[86:87], v11 offset:6400
    s_waitcnt lgkmcnt(10)
    v_mfma_f32_16x16x32_bf16 v[24:27], v[64:67], v[96:99], 0
    v_mfma_f32_16x16x32_bf16 v[28:31], v[64:67], v[100:103], 0
    s_lshl_b32 s56, s34, 7
    s_add_u32 s56, s56, s32
    s_add_u32 s34, s34, 1
    s_cmp_eq_u32 s34, 10
    s_cselect_b32 s34, 0, s34
    s_add_u32 m0, s36, 0
    s_nop 0
    buffer_load_dwordx4 v4, s[8:11], s56 offen lds
    ds_read_b64_tr_b16 v[88:89], v11 offset:5128
    ds_read_b64_tr_b16 v[90:91], v11 offset:6408
    s_waitcnt lgkmcnt(10)
    v_mfma_f32_16x16x32_bf16 v[32:35], v[68:71], v[96:99], 0
    v_mfma_f32_16x16x32_bf16 v[36:39], v[68:71], v[100:103], 0
    s_add_u32 s56, s56, 10240
    s_add_u32 m0, s36, 1024
    s_nop 0
    buffer_load_dwordx4 v5, s[8:11], s56 offen lds
    ds_read_b64_tr_b16 v[92:93], v12 offset:5120
    ds_read_b64_tr_b16 v[94:95], v12 offset:6400
    s_waitcnt lgkmcnt(10)
    v_mfma_f32_16x16x32_bf16 v[40:43], v[72:75], v[96:99], 0
    v_mfma_f32_16x16x32_bf16 v[44:47], v[72:75], v[100:103], 0
    s_add_u32 s56, s56, 10240
    s_add_u32 m0, s36, 2048
    s_nop 0
    buffer_load_dwordx4 v4, s[8:11], s56 offen lds
    ds_read_b64_tr_b16 v[64:65], v13 offset:5120
    ds_read_b64_tr_b16 v[66:67], v13 offset:6400
    s_waitcnt lgkmcnt(10)
    v_mfma_f32_16x16x32_bf16 v[48:51], v[76:79], v[96:99], 0
    v_mfma_f32_16x16x32_bf16 v[52:55], v[76:79], v[100:103], 0
    s_add_u32 s56, s56, 10240
    s_add_u32 m0, s36, 3072
    s_nop 0
    buffer_load_dwordx4 v5, s[8:11], s56 offen lds
    ds_read_b64_tr_b16 v[68:69], v13 offset:5128
    ds_read_b64_tr_b16 v[70:71], v13 offset:6408
    s_waitcnt lgkmcnt(10)
    v_mfma_f32_16x16x32_bf16 v[56:59], v[80:83], v[96:99], 0
    v_mfma_f32_16x16x32_bf16 v[60:63], v[80:83], v[100:103], 0
    s_lshl_b32 s56, s34, 7
    s_add_u32 s56, s56, s32
    s_add_u32 s34, s34, 1
    s_cmp_eq_u32 s34, 10
    s_cselect_b32 s34, 0, s34
    s_add_u32 m0, s36, 4096
    s_nop 0
    buffer_load_dwordx4 v4, s[8:11], s56 offen lds
    s_add_u32 s56, s56, 10240
    s_add_u32 m0, s36, 5120
    s_nop 0
    buffer_load_dwordx4 v5, s[8:11], s56 offen lds
    ds_read_b64_tr_b16 v[72:73], v11 offset:10240
    ds_read_b64_tr_b16 v[74:75], v11 offset:11520
    s_waitcnt lgkmcnt(10)
    v_mfma_f32_16x16x32_bf16 v[24:27], v[84:87], v[104:107], v[24:27]
    v_mfma_f32_16x16x32_bf16 v[28:31], v[84:87], v[108:111], v[28:31]
    s_add_u32 s56, s56, 10240
    s_add_u32 m0, s36, 6144
    s_nop 0
    buffer_load_dwordx4 v4, s[8:11], s56 offen lds
    s_add_u32 s56, s56, 10240
    s_add_u32 m0, s36, 7168
    s_nop 0
    buffer_load_dwordx4 v5, s[8:11], s56 offen lds
    ds_read_b64_tr_b16 v[76:77], v11 offset:10248
    ds_read_b64_tr_b16 v[78:79], v11 offset:11528
    s_waitcnt lgkmcnt(10)
    v_mfma_f32_16x16x32_bf16 v[32:35], v[88:91], v[104:107], v[32:35]
    v_mfma_f32_16x16x32_bf16 v[36:39], v[88:91], v[108:111], v[36:39]
    s_mul_i32 s57, s35, 245760
    s_add_u32 s57, s57, s33
    s_add_u32 s35, s35, 1
    s_cmp_eq_u32 s35, 10
    s_cselect_b32 s35, 0, s35
    s_add_u32 m0, s37, 30720
    s_nop 0
    buffer_load_dwordx4 v8, s[12:15], s57 offen lds
    s_add_u32 m0, s37, 31744
    s_nop 0
    buffer_load_dwordx4 v9, s[12:15], s57 offen lds
    ds_read_b64_tr_b16 v[80:81], v12 offset:10240
    ds_read_b64_tr_b16 v[82:83], v12 offset:11520
    s_waitcnt lgkmcnt(10)
    v_mfma_f32_16x16x32_bf16 v[40:43], v[92:95], v[104:107], v[40:43]
    v_mfma_f32_16x16x32_bf16 v[44:47], v[92:95], v[108:111], v[44:47]
    s_mov_b32 exec_hi, 0
    s_add_u32 m0, s37, 32768
    s_nop 0
    buffer_load_dwordx4 v10, s[12:15], s57 offen lds
    s_mov_b32 exec_hi, -1
    ds_read_b64_tr_b16 v[84:85], v13 offset:10240
    ds_read_b64_tr_b16 v[86:87], v13 offset:11520
    s_waitcnt lgkmcnt(10)
    v_mfma_f32_16x16x32_bf16 v[48:51], v[64:67], v[104:107], v[48:51]
    v_mfma_f32_16x16x32_bf16 v[52:55], v[64:67], v[108:111], v[52:55]
    ds_read_b64_tr_b16 v[88:89], v13 offset:10248
    ds_read_b64_tr_b16 v[90:91], v13 offset:11528
    s_waitcnt lgkmcnt(10)
    v_mfma_f32_16x16x32_bf16 v[56:59], v[68:71], v[104:107], v[56:59]
    v_mfma_f32_16x16x32_bf16 v[60:63], v[68:71], v[108:111], v[60:63]
    s_waitcnt vmcnt(7)
    s_barrier
    ds_read_b128 v[128:131], v6 offset:0
    ds_read_b128 v[132:135], v6 offset:2048
    ds_read_b128 v[136:139], v7 offset:0
    ds_read_b128 v[140:143], v7 offset:2048
    ds_read_b64_tr_b16 v[92:93], v11 offset:15360
    ds_read_b64_tr_b16 v[94:95], v11 offset:16640
    s_waitcnt lgkmcnt(14)
    v_mfma_f32_16x16x32_bf16 v[24:27], v[72:75], v[112:115], v[24:27]
    v_mfma_f32_16x16x32_bf16 v[28:31], v[72:75], v[116:119], v[28:31]
    ds_read_b64_tr_b16 v[64:65], v11 offset:15368
    ds_read_b64_tr_b16 v[66:67], v11 offset:16648
    s_waitcnt lgkmcnt(14)
    v_mfma_f32_16x16x32_bf16 v[32:35], v[76:79], v[112:115], v[32:35]
    v_mfma_f32_16x16x32_bf16 v[36:39], v[76:79], v[116:119], v[36:39]
    ds_read_b64_tr_b16 v[68:69], v12 offset:15360
    ds_read_b64_tr_b16 v[70:71], v12 offset:16640
    s_waitcnt lgkmcnt(14)
    v_mfma_f32_16x16x32_bf16 v[40:43], v[80:83], v[112:115], v[40:43]
    v_mfma_f32_16x16x32_bf16 v[44:47], v[80:83], v[116:119], v[44:47]
    ds_read_b64_tr_b16 v[72:73], v13 offset:15360
    ds_read_b64_tr_b16 v[74:75], v13 offset:16640
    s_waitcnt lgkmcnt(8)
    v_mfma_f32_16x16x32_bf16 v[48:51], v[84:87], v[112:115], v[48:51]
    v_mfma_f32_16x16x32_bf16 v[52:55], v[84:87], v[116:119], v[52:55]
    s_lshl_b32 s56, s34, 7
    s_add_u32 s56, s56, s32
    s_add_u32 s34, s34, 1
    s_cmp_eq_u32 s34, 10
    s_cselect_b32 s34, 0, s34
    s_add_u32 m0, s36, 0
    s_nop 0
    buffer_load_dwordx4 v4, s[8:11], s56 offen lds
    ds_read_b64_tr_b16 v[76:77], v13 offset:15368
    ds_read_b64_tr_b16 v[78:79], v13 offset:16648
    v_mfma_f32_16x16x32_bf16 v[56:59], v[88:91], v[112:115], v[56:59]
    v_mfma_f32_16x16x32_bf16 v[60:63], v[88:91], v[116:119], v[60:63]
    s_add_u32 s56, s56, 10240
    s_add_u32 m0, s36, 1024
    s_nop 0
    buffer_load_dwordx4 v5, s[8:11], s56 offen lds
    s_add_u32 s56, s56, 10240
    s_add_u32 m0, s36, 2048
    s_nop 0
    buffer_load_dwordx4 v4, s[8:11], s56 offen lds
    ds_read_b64_tr_b16 v[80:81], v11 offset:20480
    ds_read_b64_tr_b16 v[82:83], v11 offset:21760
    s_waitcnt lgkmcnt(10)
    v_mfma_f32_16x16x32_bf16 v[24:27], v[92:95], v[120:123], v[24:27]
    v_mfma_f32_16x16x32_bf16 v[28:31], v[92:95], v[124:127], v[28:31]
    s_add_u32 s56, s56, 10240
    s_add_u32 m0, s36, 3072
    s_nop 0
    buffer_load_dwordx4 v5, s[8:11], s56 offen lds
    s_mul_i32 s57, s35, 245760
    s_add_u32 s57, s57, s33
    s_add_u32 s35, s35, 1
    s_cmp_eq_u32 s35, 10
    s_cselect_b32 s35, 0, s35
    s_add_u32 m0, s37, 0
    s_nop 0
    buffer_load_dwordx4 v8, s[12:15], s57 offen lds
    ds_read_b64_tr_b16 v[84:85], v11 offset:20488
    ds_read_b64_tr_b16 v[86:87], v11 offset:21768
    s_waitcnt lgkmcnt(10)
    v_mfma_f32_16x16x32_bf16 v[32:35], v[64:67], v[120:123], v[32:35]
    v_mfma_f32_16x16x32_bf16 v[36:39], v[64:67], v[124:127], v[36:39]
    s_add_u32 m0, s37, 1024
    s_nop 0
    buffer_load_dwordx4 v9, s[12:15], s57 offen lds
    s_mov_b32 exec_hi, 0
    s_add_u32 m0, s37, 2048
    s_nop 0
    buffer_load_dwordx4 v10, s[12:15], s57 offen lds
    s_mov_b32 exec_hi, -1
    ds_read_b64_tr_b16 v[88:89], v12 offset:20480
    ds_read_b64_tr_b16 v[90:91], v12 offset:21760
    s_waitcnt lgkmcnt(10)
    v_mfma_f32_16x16x32_bf16 v[40:43], v[68:71], v[120:123], v[40:43]
    v_mfma_f32_16x16x32_bf16 v[44:47], v[68:71], v[124:127], v[44:47]
    ds_read_b64_tr_b16 v[92:93], v13 offset:20480
    ds_read_b64_tr_b16 v[94:95], v13 offset:21760
    s_waitcnt lgkmcnt(10)
    v_mfma_f32_16x16x32_bf16 v[48:51], v[72:75], v[120:123], v[48:51]
    v_mfma_f32_16x16x32_bf16 v[52:55], v[72:75], v[124:127], v[52:55]
    ds_read_b64_tr_b16 v[64:65], v13 offset:20488
    ds_read_b64_tr_b16 v[66:67], v13 offset:21768
    s_waitcnt lgkmcnt(10)
    v_mfma_f32_16x16x32_bf16 v[56:59], v[76:79], v[120:123], v[56:59]
    v_mfma_f32_16x16x32_bf16 v[60:63], v[76:79], v[124:127], v[60:63]
    s_waitcnt vmcnt(7)
    s_barrier
    ds_read_b128 v[144:147], v6 offset:4096
    ds_read_b128 v[148:151], v6 offset:6144
    ds_read_b128 v[152:155], v7 offset:4096
    ds_read_b128 v[156:159], v7 offset:6144
    ds_read_b64_tr_b16 v[68:69], v11 offset:25600
    ds_read_b64_tr_b16 v[70:71], v11 offset:26880
    s_waitcnt lgkmcnt(14)
    v_mfma_f32_16x16x32_bf16 v[24:27], v[80:83], v[128:131], v[24:27]
    v_mfma_f32_16x16x32_bf16 v[28:31], v[80:83], v[132:135], v[28:31]
    ds_read_b64_tr_b16 v[72:73], v11 offset:25608
    ds_read_b64_tr_b16 v[74:75], v11 offset:26888
    s_waitcnt lgkmcnt(14)
    v_mfma_f32_16x16x32_bf16 v[32:35], v[84:87], v[128:131], v[32:35]
    v_mfma_f32_16x16x32_bf16 v[36:39], v[84:87], v[132:135], v[36:39]
    ds_read_b64_tr_b16 v[76:77], v12 offset:25600
    ds_read_b64_tr_b16 v[78:79], v12 offset:26880
    s_waitcnt lgkmcnt(14)
    v_mfma_f32_16x16x32_bf16 v[40:43], v[88:91], v[128:131], v[40:43]
    v_mfma_f32_16x16x32_bf16 v[44:47], v[88:91], v[132:135], v[44:47]
    ds_read_b64_tr_b16 v[80:81], v13 offset:25600
    ds_read_b64_tr_b16 v[82:83], v13 offset:26880
    s_waitcnt lgkmcnt(8)
    v_mfma_f32_16x16x32_bf16 v[48:51], v[92:95], v[128:131], v[48:51]
    v_mfma_f32_16x16x32_bf16 v[52:55], v[92:95], v[132:135], v[52:55]
    s_lshl_b32 s56, s34, 7
    s_add_u32 s56, s56, s32
    s_add_u32 s34, s34, 1
    s_cmp_eq_u32 s34, 10
    s_cselect_b32 s34, 0, s34
    s_add_u32 m0, s36, 4096
    s_nop 0
    buffer_load_dwordx4 v4, s[8:11], s56 offen lds
    ds_read_b64_tr_b16 v[84:85], v13 offset:25608
    ds_read_b64_tr_b16 v[86:87], v13 offset:26888
    v_mfma_f32_16x16x32_bf16 v[56:59], v[64:67], v[128:131], v[56:59]
    v_mfma_f32_16x16x32_bf16 v[60:63], v[64:67], v[132:135], v[60:63]
    s_add_u32 s56, s56, 10240
    s_add_u32 m0, s36, 5120
    s_nop 0
    buffer_load_dwordx4 v5, s[8:11], s56 offen lds
    s_add_u32 s56, s56, 10240
    s_add_u32 m0, s36, 6144
    s_nop 0
    buffer_load_dwordx4 v4, s[8:11], s56 offen lds
    ds_read_b64_tr_b16 v[88:89], v11 offset:30720
    ds_read_b64_tr_b16 v[90:91], v11 offset:32000
    s_waitcnt lgkmcnt(10)
    v_mfma_f32_16x16x32_bf16 v[24:27], v[68:71], v[136:139], v[24:27]
    v_mfma_f32_16x16x32_bf16 v[28:31], v[68:71], v[140:143], v[28:31]
    s_add_u32 s56, s56, 10240
    s_add_u32 m0, s36, 7168
    s_nop 0
    buffer_load_dwordx4 v5, s[8:11], s56 offen lds
    s_mul_i32 s57, s35, 245760
    s_add_u32 s57, s57, s33
    s_add_u32 s35, s35, 1
    s_cmp_eq_u32 s35, 10
    s_cselect_b32 s35, 0, s35
    s_add_u32 m0, s37, 10240
    s_nop 0
    buffer_load_dwordx4 v8, s[12:15], s57 offen lds
    ds_read_b64_tr_b16 v[92:93], v11 offset:30728
    ds_read_b64_tr_b16 v[94:95], v11 offset:32008
    s_waitcnt lgkmcnt(10)
    v_mfma_f32_16x16x32_bf16 v[32:35], v[72:75], v[136:139], v[32:35]
    v_mfma_f32_16x16x32_bf16 v[36:39], v[72:75], v[140:143], v[36:39]
    s_add_u32 m0, s37, 11264
    s_nop 0
    buffer_load_dwordx4 v9, s[12:15], s57 offen lds
    s_mov_b32 exec_hi, 0
    s_add_u32 m0, s37, 12288
    s_nop 0
    buffer_load_dwordx4 v10, s[12:15], s57 offen lds
    s_mov_b32 exec_hi, -1
    ds_read_b64_tr_b16 v[64:65], v12 offset:30720
    ds_read_b64_tr_b16 v[66:67], v12 offset:32000
    s_waitcnt lgkmcnt(10)
    v_mfma_f32_16x16x32_bf16 v[40:43], v[76:79], v[136:139], v[40:43]
    v_mfma_f32_16x16x32_bf16 v[44:47], v[76:79], v[140:143], v[44:47]
    ds_read_b64_tr_b16 v[68:69], v13 offset:30720
    ds_read_b64_tr_b16 v[70:71], v13 offset:32000
    s_waitcnt lgkmcnt(10)
    v_mfma_f32_16x16x32_bf16 v[48:51], v[80:83], v[136:139], v[48:51]
    v_mfma_f32_16x16x32_bf16 v[52:55], v[80:83], v[140:143], v[52:55]
    ds_read_b64_tr_b16 v[72:73], v13 offset:30728
    ds_read_b64_tr_b16 v[74:75], v13 offset:32008
    s_waitcnt lgkmcnt(10)
    v_mfma_f32_16x16x32_bf16 v[56:59], v[84:87], v[136:139], v[56:59]
    v_mfma_f32_16x16x32_bf16 v[60:63], v[84:87], v[140:143], v[60:63]
    s_waitcnt vmcnt(7)
    s_barrier
    ds_read_b128 v[160:163], v6 offset:0
    ds_read_b128 v[164:167], v6 offset:2048
    ds_read_b128 v[168:171], v7 offset:0
    ds_read_b128 v[172:175], v7 offset:2048
    ds_read_b64_tr_b16 v[76:77], v11 offset:35840
    ds_read_b64_tr_b16 v[78:79], v11 offset:37120
    s_waitcnt lgkmcnt(14)
    v_mfma_f32_16x16x32_bf16 v[24:27], v[88:91], v[144:147], v[24:27]
    v_mfma_f32_16x16x32_bf16 v[28:31], v[88:91], v[148:151], v[28:31]
    ds_read_b64_tr_b16 v[80:81], v11 offset:35848
    ds_read_b64_tr_b16 v[82:83], v11 offset:37128
    s_waitcnt lgkmcnt(14)
    v_mfma_f32_16x16x32_bf16 v[32:35], v[92:95], v[144:147], v[32:35]
    v_mfma_f32_16x16x32_bf16 v[36:39], v[92:95], v[148:151], v[36:39]
    ds_read_b64_tr_b16 v[84:85], v12 offset:35840
    ds_read_b64_tr_b16 v[86:87], v12 offset:37120
    s_waitcnt lgkmcnt(14)
    v_mfma_f32_16x16x32_bf16 v[40:43], v[64:67], v[144:147], v[40:43]
    v_mfma_f32_16x16x32_bf16 v[44:47], v[64:67], v[148:151], v[44:47]
    ds_read_b64_tr_b16 v[88:89], v13 offset:35840
    ds_read_b64_tr_b16 v[90:91], v13 offset:37120
    s_waitcnt lgkmcnt(8)
    v_mfma_f32_16x16x32_bf16 v[48:51], v[68:71], v[144:147], v[48:51]
    v_mfma_f32_16x16x32_bf16 v[52:55], v[68:71], v[148:151], v[52:55]
    s_lshl_b32 s56, s34, 7
    s_add_u32 s56, s56, s32
    s_add_u32 s34, s34, 1
    s_cmp_eq_u32 s34, 10
    s_cselect_b32 s34, 0, s34
    s_add_u32 m0, s36, 0
    s_nop 0
    buffer_load_dwordx4 v4, s[8:11], s56 offen lds
    ds_read_b64_tr_b16 v[92:93], v13 offset:35848
    ds_read_b64_tr_b16 v[94:95], v13 offset:37128
    v_mfma_f32_16x16x32_bf16 v[56:59], v[72:75], v[144:147], v[56:59]
    v_mfma_f32_16x16x32_bf16 v[60:63], v[72:75], v[148:151], v[60:63]
    s_add_u32 s56, s56, 10240
    s_add_u32 m0, s36, 1024
    s_nop 0
    buffer_load_dwordx4 v5, s[8:11], s56 offen lds
    s_add_u32 s56, s56, 10240
    s_add_u32 m0, s36, 2048
    s_nop 0
    buffer_load_dwordx4 v4, s[8:11], s56 offen lds
    ds_read_b64_tr_b16 v[64:65], v11 offset:0
    ds_read_b64_tr_b16 v[66:67], v11 offset:1280
    s_waitcnt lgkmcnt(10)
    v_mfma_f32_16x16x32_bf16 v[24:27], v[76:79], v[152:155], v[24:27]
    v_mfma_f32_16x16x32_bf16 v[28:31], v[76:79], v[156:159], v[28:31]
    s_add_u32 s56, s56, 10240
    s_add_u32 m0, s36, 3072
    s_nop 0
    buffer_load_dwordx4 v5, s[8:11], s56 offen lds
    s_mul_i32 s57, s35, 245760
    s_add_u32 s57, s57, s33
    s_add_u32 s35, s35, 1
    s_cmp_eq_u32 s35, 10
    s_cselect_b32 s35, 0, s35
    s_add_u32 m0, s37, 20480
    s_nop 0
    buffer_load_dwordx4 v8, s[12:15], s57 offen lds
    ds_read_b64_tr_b16 v[68:69], v11 offset:8
    ds_read_b64_tr_b16 v[70:71], v11 offset:1288
    s_waitcnt lgkmcnt(10)
    v_mfma_f32_16x16x32_bf16 v[32:35], v[80:83], v[152:155], v[32:35]
    v_mfma_f32_16x16x32_bf16 v[36:39], v[80:83], v[156:159], v[36:39]
    s_add_u32 m0, s37, 21504
    s_nop 0
    buffer_load_dwordx4 v9, s[12:15], s57 offen lds
    s_mov_b32 exec_hi, 0
    s_add_u32 m0, s37, 22528
    s_nop 0
    buffer_load_dwordx4 v10, s[12:15], s57 offen lds
    s_mov_b32 exec_hi, -1
    ds_read_b64_tr_b16 v[72:73], v12 offset:0
    ds_read_b64_tr_b16 v[74:75], v12 offset:1280
    s_waitcnt lgkmcnt(10)
    v_mfma_f32_16x16x32_bf16 v[40:43], v[84:87], v[152:155], v[40:43]
    v_mfma_f32_16x16x32_bf16 v[44:47], v[84:87], v[156:159], v[44:47]
    ds_read_b64_tr_b16 v[76:77], v13 offset:0
    ds_read_b64_tr_b16 v[78:79], v13 offset:1280
    s_waitcnt lgkmcnt(10)
    v_mfma_f32_16x16x32_bf16 v[48:51], v[88:91], v[152:155], v[48:51]
    v_mfma_f32_16x16x32_bf16 v[52:55], v[88:91], v[156:159], v[52:55]
    ds_read_b64_tr_b16 v[80:81], v13 offset:8
    ds_read_b64_tr_b16 v[82:83], v13 offset:1288
    s_waitcnt lgkmcnt(10)
    v_mfma_f32_16x16x32_bf16 v[56:59], v[92:95], v[152:155], v[56:59]
    v_mfma_f32_16x16x32_bf16 v[60:63], v[92:95], v[156:159], v[60:63]
    s_waitcnt vmcnt(7)
    s_barrier
    ds_read_b128 v[176:179], v6 offset:4096
    ds_read_b128 v[180:183], v6 offset:6144
    ds_read_b128 v[184:187], v7 offset:4096
    ds_read_b128 v[188:191], v7 offset:6144
    ds_read_b64_tr_b16 v[84:85], v11 offset:5120
    ds_read_b64_tr_b16 v[86:87], v11 offset:6400
    s_waitcnt lgkmcnt(14)
    v_mfma_f32_16x16x32_bf16 v[24:27], v[64:67], v[160:163], v[24:27]
    v_mfma_f32_16x16x32_bf16 v[28:31], v[64:67], v[164:167], v[28:31]
    ds_read_b64_tr_b16 v[88:89], v11 offset:5128
    ds_read_b64_tr_b16 v[90:91], v11 offset:6408
    s_waitcnt lgkmcnt(14)
    v_mfma_f32_16x16x32_bf16 v[32:35], v[68:71], v[160:163], v[32:35]
    v_mfma_f32_16x16x32_bf16 v[36:39], v[68:71], v[164:167], v[36:39]
    ds_read_b64_tr_b16 v[92:93], v12 offset:5120
    ds_read_b64_tr_b16 v[94:95], v12 offset:6400
    s_waitcnt lgkmcnt(14)
    v_mfma_f32_16x16x32_bf16 v[40:43], v[72:75], v[160:163], v[40:43]
    v_mfma_f32_16x16x32_bf16 v[44:47], v[72:75], v[164:167], v[44:47]
    ds_read_b64_tr_b16 v[64:65], v13 offset:5120
    ds_read_b64_tr_b16 v[66:67], v13 offset:6400
    s_waitcnt lgkmcnt(8)
    v_mfma_f32_16x16x32_bf16 v[48:51], v[76:79], v[160:163], v[48:51]
    v_mfma_f32_16x16x32_bf16 v[52:55], v[76:79], v[164:167], v[52:55]
    s_lshl_b32 s56, s34, 7
    s_add_u32 s56, s56, s32
    s_add_u32 s34, s34, 1
    s_cmp_eq_u32 s34, 10
    s_cselect_b32 s34, 0, s34
    s_add_u32 m0, s36, 4096
    s_nop 0
    buffer_load_dwordx4 v4, s[8:11], s56 offen lds
    ds_read_b64_tr_b16 v[68:69], v13 offset:5128
    ds_read_b64_tr_b16 v[70:71], v13 offset:6408
    v_mfma_f32_16x16x32_bf16 v[56:59], v[80:83], v[160:163], v[56:59]
    v_mfma_f32_16x16x32_bf16 v[60:63], v[80:83], v[164:167], v[60:63]
    s_add_u32 s56, s56, 10240
    s_add_u32 m0, s36, 5120
    s_nop 0
    buffer_load_dwordx4 v5, s[8:11], s56 offen lds
    s_add_u32 s56, s56, 10240
    s_add_u32 m0, s36, 6144
    s_nop 0
    buffer_load_dwordx4 v4, s[8:11], s56 offen lds
    ds_read_b64_tr_b16 v[72:73], v11 offset:10240
    ds_read_b64_tr_b16 v[74:75], v11 offset:11520
    s_waitcnt lgkmcnt(10)
    v_mfma_f32_16x16x32_bf16 v[24:27], v[84:87], v[168:171], v[24:27]
    v_mfma_f32_16x16x32_bf16 v[28:31], v[84:87], v[172:175], v[28:31]
    s_add_u32 s56, s56, 10240
    s_add_u32 m0, s36, 7168
    s_nop 0
    buffer_load_dwordx4 v5, s[8:11], s56 offen lds
    s_mul_i32 s57, s35, 245760
    s_add_u32 s57, s57, s33
    s_add_u32 s35, s35, 1
    s_cmp_eq_u32 s35, 10
    s_cselect_b32 s35, 0, s35
    s_add_u32 m0, s37, 30720
    s_nop 0
    buffer_load_dwordx4 v8, s[12:15], s57 offen lds
    ds_read_b64_tr_b16 v[76:77], v11 offset:10248
    ds_read_b64_tr_b16 v[78:79], v11 offset:11528
    s_waitcnt lgkmcnt(10)
    v_mfma_f32_16x16x32_bf16 v[32:35], v[88:91], v[168:171], v[32:35]
    v_mfma_f32_16x16x32_bf16 v[36:39], v[88:91], v[172:175], v[36:39]
    s_add_u32 m0, s37, 31744
    s_nop 0
    buffer_load_dwordx4 v9, s[12:15], s57 offen lds
    s_mov_b32 exec_hi, 0
    s_add_u32 m0, s37, 32768
    s_nop 0
    buffer_load_dwordx4 v10, s[12:15], s57 offen lds
    s_mov_b32 exec_hi, -1
    ds_read_b64_tr_b16 v[80:81], v12 offset:10240
    ds_read_b64_tr_b16 v[82:83], v12 offset:11520
    s_waitcnt lgkmcnt(10)
    v_mfma_f32_16x16x32_bf16 v[40:43], v[92:95], v[168:171], v[40:43]
    v_mfma_f32_16x16x32_bf16 v[44:47], v[92:95], v[172:175], v[44:47]
    ds_read_b64_tr_b16 v[84:85], v13 offset:10240
    ds_read_b64_tr_b16 v[86:87], v13 offset:11520
    s_waitcnt lgkmcnt(10)
    v_mfma_f32_16x16x32_bf16 v[48:51], v[64:67], v[168:171], v[48:51]
    v_mfma_f32_16x16x32_bf16 v[52:55], v[64:67], v[172:175], v[52:55]
    ds_read_b64_tr_b16 v[88:89], v13 offset:10248
    ds_read_b64_tr_b16 v[90:91], v13 offset:11528
    s_waitcnt lgkmcnt(10)
    v_mfma_f32_16x16x32_bf16 v[56:59], v[68:71], v[168:171], v[56:59]
    v_mfma_f32_16x16x32_bf16 v[60:63], v[68:71], v[172:175], v[60:63]
    s_waitcnt vmcnt(7)
    s_barrier
    ds_read_b128 v[192:195], v6 offset:0
    ds_read_b128 v[196:199], v6 offset:2048
    ds_read_b128 v[200:203], v7 offset:0
    ds_read_b128 v[204:207], v7 offset:2048
    ds_read_b64_tr_b16 v[92:93], v11 offset:15360
    ds_read_b64_tr_b16 v[94:95], v11 offset:16640
    s_waitcnt lgkmcnt(14)
    v_mfma_f32_16x16x32_bf16 v[24:27], v[72:75], v[176:179], v[24:27]
    v_mfma_f32_16x16x32_bf16 v[28:31], v[72:75], v[180:183], v[28:31]
    ds_read_b64_tr_b16 v[64:65], v11 offset:15368
    ds_read_b64_tr_b16 v[66:67], v11 offset:16648
    s_waitcnt lgkmcnt(14)
    v_mfma_f32_16x16x32_bf16 v[32:35], v[76:79], v[176:179], v[32:35]
    v_mfma_f32_16x16x32_bf16 v[36:39], v[76:79], v[180:183], v[36:39]
    ds_read_b64_tr_b16 v[68:69], v12 offset:15360
    ds_read_b64_tr_b16 v[70:71], v12 offset:16640
    s_waitcnt lgkmcnt(14)
    v_mfma_f32_16x16x32_bf16 v[40:43], v[80:83], v[176:179], v[40:43]
    v_mfma_f32_16x16x32_bf16 v[44:47], v[80:83], v[180:183], v[44:47]
    ds_read_b64_tr_b16 v[72:73], v13 offset:15360
    ds_read_b64_tr_b16 v[74:75], v13 offset:16640
    s_waitcnt lgkmcnt(8)
    v_mfma_f32_16x16x32_bf16 v[48:51], v[84:87], v[176:179], v[48:51]
    v_mfma_f32_16x16x32_bf16 v[52:55], v[84:87], v[180:183], v[52:55]
    s_lshl_b32 s56, s34, 7
    s_add_u32 s56, s56, s32
    s_add_u32 s34, s34, 1
    s_cmp_eq_u32 s34, 10
    s_cselect_b32 s34, 0, s34
    s_add_u32 m0, s36, 0
    s_nop 0
    buffer_load_dwordx4 v4, s[8:11], s56 offen lds
    ds_read_b64_tr_b16 v[76:77], v13 offset:15368
    ds_read_b64_tr_b16 v[78:79], v13 offset:16648
    v_mfma_f32_16x16x32_bf16 v[56:59], v[88:91], v[176:179], v[56:59]
    v_mfma_f32_16x16x32_bf16 v[60:63], v[88:91], v[180:183], v[60:63]
    s_add_u32 s56, s56, 10240
    s_add_u32 m0, s36, 1024
    s_nop 0
    buffer_load_dwordx4 v5, s[8:11], s56 offen lds
    s_add_u32 s56, s56, 10240
    s_add_u32 m0, s36, 2048
    s_nop 0
    buffer_load_dwordx4 v4, s[8:11], s56 offen lds
    ds_read_b64_tr_b16 v[80:81], v11 offset:20480
    ds_read_b64_tr_b16 v[82:83], v11 offset:21760
    s_waitcnt lgkmcnt(10)
    v_mfma_f32_16x16x32_bf16 v[24:27], v[92:95], v[184:187], v[24:27]
    v_mfma_f32_16x16x32_bf16 v[28:31], v[92:95], v[188:191], v[28:31]
    s_add_u32 s56, s56, 10240
    s_add_u32 m0, s36, 3072
    s_nop 0
    buffer_load_dwordx4 v5, s[8:11], s56 offen lds
    s_mul_i32 s57, s35, 245760
    s_add_u32 s57, s57, s33
    s_add_u32 s35, s35, 1
    s_cmp_eq_u32 s35, 10
    s_cselect_b32 s35, 0, s35
    s_add_u32 m0, s37, 0
    s_nop 0
    buffer_load_dwordx4 v8, s[12:15], s57 offen lds
    ds_read_b64_tr_b16 v[84:85], v11 offset:20488
    ds_read_b64_tr_b16 v[86:87], v11 offset:21768
    s_waitcnt lgkmcnt(10)
    v_mfma_f32_16x16x32_bf16 v[32:35], v[64:67], v[184:187], v[32:35]
    v_mfma_f32_16x16x32_bf16 v[36:39], v[64:67], v[188:191], v[36:39]
    s_add_u32 m0, s37, 1024
    s_nop 0
    buffer_load_dwordx4 v9, s[12:15], s57 offen lds
    s_mov_b32 exec_hi, 0
    s_add_u32 m0, s37, 2048
    s_nop 0
    buffer_load_dwordx4 v10, s[12:15], s57 offen lds
    s_mov_b32 exec_hi, -1
    ds_read_b64_tr_b16 v[88:89], v12 offset:20480
    ds_read_b64_tr_b16 v[90:91], v12 offset:21760
    s_waitcnt lgkmcnt(10)
    v_mfma_f32_16x16x32_bf16 v[40:43], v[68:71], v[184:187], v[40:43]
    v_mfma_f32_16x16x32_bf16 v[44:47], v[68:71], v[188:191], v[44:47]
    ds_read_b64_tr_b16 v[92:93], v13 offset:20480
    ds_read_b64_tr_b16 v[94:95], v13 offset:21760
    s_waitcnt lgkmcnt(10)
    v_mfma_f32_16x16x32_bf16 v[48:51], v[72:75], v[184:187], v[48:51]
    v_mfma_f32_16x16x32_bf16 v[52:55], v[72:75], v[188:191], v[52:55]
    ds_read_b64_tr_b16 v[64:65], v13 offset:20488
    ds_read_b64_tr_b16 v[66:67], v13 offset:21768
    s_waitcnt lgkmcnt(10)
    v_mfma_f32_16x16x32_bf16 v[56:59], v[76:79], v[184:187], v[56:59]
    v_mfma_f32_16x16x32_bf16 v[60:63], v[76:79], v[188:191], v[60:63]
    s_waitcnt vmcnt(7)
    s_barrier
    ds_read_b128 v[208:211], v6 offset:4096
    ds_read_b128 v[212:215], v6 offset:6144
    ds_read_b128 v[216:219], v7 offset:4096
    ds_read_b128 v[220:223], v7 offset:6144
    ds_read_b64_tr_b16 v[68:69], v11 offset:25600
    ds_read_b64_tr_b16 v[70:71], v11 offset:26880
    s_waitcnt lgkmcnt(14)
    v_mfma_f32_16x16x32_bf16 v[24:27], v[80:83], v[192:195], v[24:27]
    v_mfma_f32_16x16x32_bf16 v[28:31], v[80:83], v[196:199], v[28:31]
    ds_read_b64_tr_b16 v[72:73], v11 offset:25608
    ds_read_b64_tr_b16 v[74:75], v11 offset:26888
    s_waitcnt lgkmcnt(14)
    v_mfma_f32_16x16x32_bf16 v[32:35], v[84:87], v[192:195], v[32:35]
    v_mfma_f32_16x16x32_bf16 v[36:39], v[84:87], v[196:199], v[36:39]
    ds_read_b64_tr_b16 v[76:77], v12 offset:25600
    ds_read_b64_tr_b16 v[78:79], v12 offset:26880
    s_waitcnt lgkmcnt(14)
    v_mfma_f32_16x16x32_bf16 v[40:43], v[88:91], v[192:195], v[40:43]
    v_mfma_f32_16x16x32_bf16 v[44:47], v[88:91], v[196:199], v[44:47]
    ds_read_b64_tr_b16 v[80:81], v13 offset:25600
    ds_read_b64_tr_b16 v[82:83], v13 offset:26880
    s_waitcnt lgkmcnt(8)
    v_mfma_f32_16x16x32_bf16 v[48:51], v[92:95], v[192:195], v[48:51]
    v_mfma_f32_16x16x32_bf16 v[52:55], v[92:95], v[196:199], v[52:55]
    s_lshl_b32 s56, s34, 7
    s_add_u32 s56, s56, s32
    s_add_u32 s34, s34, 1
    s_cmp_eq_u32 s34, 10
    s_cselect_b32 s34, 0, s34
    s_add_u32 m0, s36, 4096
    s_nop 0
    buffer_load_dwordx4 v4, s[8:11], s56 offen lds
    ds_read_b64_tr_b16 v[84:85], v13 offset:25608
    ds_read_b64_tr_b16 v[86:87], v13 offset:26888
    v_mfma_f32_16x16x32_bf16 v[56:59], v[64:67], v[192:195], v[56:59]
    v_mfma_f32_16x16x32_bf16 v[60:63], v[64:67], v[196:199], v[60:63]
    s_add_u32 s56, s56, 10240
    s_add_u32 m0, s36, 5120
    s_nop 0
    buffer_load_dwordx4 v5, s[8:11], s56 offen lds
    s_add_u32 s56, s56, 10240
    s_add_u32 m0, s36, 6144
    s_nop 0
    buffer_load_dwordx4 v4, s[8:11], s56 offen lds
    ds_read_b64_tr_b16 v[88:89], v11 offset:30720
    ds_read_b64_tr_b16 v[90:91], v11 offset:32000
    s_waitcnt lgkmcnt(10)
    v_mfma_f32_16x16x32_bf16 v[24:27], v[68:71], v[200:203], v[24:27]
    v_mfma_f32_16x16x32_bf16 v[28:31], v[68:71], v[204:207], v[28:31]
    s_add_u32 s56, s56, 10240
    s_add_u32 m0, s36, 7168
    s_nop 0
    buffer_load_dwordx4 v5, s[8:11], s56 offen lds
    s_mul_i32 s57, s35, 245760
    s_add_u32 s57, s57, s33
    s_add_u32 s35, s35, 1
    s_cmp_eq_u32 s35, 10
    s_cselect_b32 s35, 0, s35
    s_add_u32 m0, s37, 10240
    s_nop 0
    buffer_load_dwordx4 v8, s[12:15], s57 offen lds
    ds_read_b64_tr_b16 v[92:93], v11 offset:30728
    ds_read_b64_tr_b16 v[94:95], v11 offset:32008
    s_waitcnt lgkmcnt(10)
    v_mfma_f32_16x16x32_bf16 v[32:35], v[72:75], v[200:203], v[32:35]
    v_mfma_f32_16x16x32_bf16 v[36:39], v[72:75], v[204:207], v[36:39]
    s_add_u32 m0, s37, 11264
    s_nop 0
    buffer_load_dwordx4 v9, s[12:15], s57 offen lds
    s_mov_b32 exec_hi, 0
    s_add_u32 m0, s37, 12288
    s_nop 0
    buffer_load_dwordx4 v10, s[12:15], s57 offen lds
    s_mov_b32 exec_hi, -1
    ds_read_b64_tr_b16 v[64:65], v12 offset:30720
    ds_read_b64_tr_b16 v[66:67], v12 offset:32000
    s_waitcnt lgkmcnt(10)
    v_mfma_f32_16x16x32_bf16 v[40:43], v[76:79], v[200:203], v[40:43]
    v_mfma_f32_16x16x32_bf16 v[44:47], v[76:79], v[204:207], v[44:47]
    ds_read_b64_tr_b16 v[68:69], v13 offset:30720
    ds_read_b64_tr_b16 v[70:71], v13 offset:32000
    s_waitcnt lgkmcnt(10)
    v_mfma_f32_16x16x32_bf16 v[48:51], v[80:83], v[200:203], v[48:51]
    v_mfma_f32_16x16x32_bf16 v[52:55], v[80:83], v[204:207], v[52:55]
    ds_read_b64_tr_b16 v[72:73], v13 offset:30728
    ds_read_b64_tr_b16 v[74:75], v13 offset:32008
    s_waitcnt lgkmcnt(10)
    v_mfma_f32_16x16x32_bf16 v[56:59], v[84:87], v[200:203], v[56:59]
    v_mfma_f32_16x16x32_bf16 v[60:63], v[84:87], v[204:207], v[60:63]
    s_waitcnt vmcnt(7)
    s_barrier
    ds_read_b128 v[224:227], v6 offset:0
    ds_read_b128 v[228:231], v6 offset:2048
    ds_read_b128 v[232:235], v7 offset:0
    ds_read_b128 v[236:239], v7 offset:2048
    ds_read_b64_tr_b16 v[76:77], v11 offset:35840
    ds_read_b64_tr_b16 v[78:79], v11 offset:37120
    s_waitcnt lgkmcnt(14)
    v_mfma_f32_16x16x32_bf16 v[24:27], v[88:91], v[208:211], v[24:27]
    v_mfma_f32_16x16x32_bf16 v[28:31], v[88:91], v[212:215], v[28:31]
    ds_read_b64_tr_b16 v[80:81], v11 offset:35848
    ds_read_b64_tr_b16 v[82:83], v11 offset:37128
    s_waitcnt lgkmcnt(14)
    v_mfma_f32_16x16x32_bf16 v[32:35], v[92:95], v[208:211], v[32:35]
    v_mfma_f32_16x16x32_bf16 v[36:39], v[92:95], v[212:215], v[36:39]
    ds_read_b64_tr_b16 v[84:85], v12 offset:35840
    ds_read_b64_tr_b16 v[86:87], v12 offset:37120
    s_waitcnt lgkmcnt(14)
    v_mfma_f32_16x16x32_bf16 v[40:43], v[64:67], v[208:211], v[40:43]
    v_mfma_f32_16x16x32_bf16 v[44:47], v[64:67], v[212:215], v[44:47]
    ds_read_b64_tr_b16 v[88:89], v13 offset:35840
    ds_read_b64_tr_b16 v[90:91], v13 offset:37120
    s_waitcnt lgkmcnt(14)
    v_mfma_f32_16x16x32_bf16 v[48:51], v[68:71], v[208:211], v[48:51]
    v_mfma_f32_16x16x32_bf16 v[52:55], v[68:71], v[212:215], v[52:55]
    ds_read_b64_tr_b16 v[92:93], v13 offset:35848
    ds_read_b64_tr_b16 v[94:95], v13 offset:37128
    s_waitcnt lgkmcnt(14)
    v_mfma_f32_16x16x32_bf16 v[56:59], v[72:75], v[208:211], v[56:59]
    v_mfma_f32_16x16x32_bf16 v[60:63], v[72:75], v[212:215], v[60:63]
    ds_read_b64_tr_b16 v[64:65], v11 offset:0
    ds_read_b64_tr_b16 v[66:67], v11 offset:1280
    s_waitcnt lgkmcnt(10)
    v_mfma_f32_16x16x32_bf16 v[24:27], v[76:79], v[216:219], v[24:27]
    v_mfma_f32_16x16x32_bf16 v[28:31], v[76:79], v[220:223], v[28:31]
    ds_read_b64_tr_b16 v[68:69], v11 offset:8
    ds_read_b64_tr_b16 v[70:71], v11 offset:1288
    s_waitcnt lgkmcnt(10)
    v_mfma_f32_16x16x32_bf16 v[32:35], v[80:83], v[216:219], v[32:35]
    v_mfma_f32_16x16x32_bf16 v[36:39], v[80:83], v[220:223], v[36:39]
    ds_read_b64_tr_b16 v[72:73], v12 offset:0
    ds_read_b64_tr_b16 v[74:75], v12 offset:1280
    s_waitcnt lgkmcnt(10)
    v_mfma_f32_16x16x32_bf16 v[40:43], v[84:87], v[216:219], v[40:43]
    v_mfma_f32_16x16x32_bf16 v[44:47], v[84:87], v[220:223], v[44:47]
    ds_read_b64_tr_b16 v[76:77], v13 offset:0
    ds_read_b64_tr_b16 v[78:79], v13 offset:1280
    s_waitcnt lgkmcnt(10)
    v_mfma_f32_16x16x32_bf16 v[48:51], v[88:91], v[216:219], v[48:51]
    v_mfma_f32_16x16x32_bf16 v[52:55], v[88:91], v[220:223], v[52:55]
    ds_read_b64_tr_b16 v[80:81], v13 offset:8
    ds_read_b64_tr_b16 v[82:83], v13 offset:1288
    s_waitcnt lgkmcnt(10)
    v_mfma_f32_16x16x32_bf16 v[56:59], v[92:95], v[216:219], v[56:59]
    v_mfma_f32_16x16x32_bf16 v[60:63], v[92:95], v[220:223], v[60:63]
    s_waitcnt vmcnt(0)
    s_barrier
    ds_read_b128 v[240:243], v6 offset:4096
    ds_read_b128 v[244:247], v6 offset:6144
    ds_read_b128 v[248:251], v7 offset:4096
    ds_read_b128 v[252:255], v7 offset:6144
    ds_read_b64_tr_b16 v[84:85], v11 offset:5120
    ds_read_b64_tr_b16 v[86:87], v11 offset:6400
    s_waitcnt lgkmcnt(14)
    v_mfma_f32_16x16x32_bf16 v[24:27], v[64:67], v[224:227], v[24:27]
    v_mfma_f32_16x16x32_bf16 v[28:31], v[64:67], v[228:231], v[28:31]
    s_sub_u32 s57, s40, 10
    s_cmp_ge_u32 s40, 10
    s_cselect_b32 s40, s57, s40
    s_mul_i32 s57, s40, 245760
    s_add_u32 s57, s57, s39
    s_add_u32 s40, s40, 2
    s_add_u32 m0, s38, 33280
    s_nop 0
    buffer_load_dwordx4 v14, s[12:15], s57 offen lds
    ds_read_b64_tr_b16 v[88:89], v11 offset:5128
    ds_read_b64_tr_b16 v[90:91], v11 offset:6408
    s_waitcnt lgkmcnt(14)
    v_mfma_f32_16x16x32_bf16 v[32:35], v[68:71], v[224:227], v[32:35]
    v_mfma_f32_16x16x32_bf16 v[36:39], v[68:71], v[228:231], v[36:39]
    s_add_u32 m0, s38, 34304
    s_nop 0
    buffer_load_dwordx4 v15, s[12:15], s57 offen lds
    ds_read_b64_tr_b16 v[92:93], v12 offset:5120
    ds_read_b64_tr_b16 v[94:95], v12 offset:6400
    s_waitcnt lgkmcnt(14)
    v_mfma_f32_16x16x32_bf16 v[40:43], v[72:75], v[224:227], v[40:43]
    v_mfma_f32_16x16x32_bf16 v[44:47], v[72:75], v[228:231], v[44:47]
    s_mov_b32 exec_hi, 0
    s_add_u32 m0, s38, 35328
    s_nop 0
    buffer_load_dwordx4 v16, s[12:15], s57 offen lds
    s_mov_b32 exec_hi, -1
    ds_read_b64_tr_b16 v[64:65], v13 offset:5120
    ds_read_b64_tr_b16 v[66:67], v13 offset:6400
    s_waitcnt lgkmcnt(14)
    v_mfma_f32_16x16x32_bf16 v[48:51], v[76:79], v[224:227], v[48:51]
    v_mfma_f32_16x16x32_bf16 v[52:55], v[76:79], v[228:231], v[52:55]
    ds_read_b64_tr_b16 v[68:69], v13 offset:5128
    ds_read_b64_tr_b16 v[70:71], v13 offset:6408
    s_waitcnt lgkmcnt(14)
    v_mfma_f32_16x16x32_bf16 v[56:59], v[80:83], v[224:227], v[56:59]
    v_mfma_f32_16x16x32_bf16 v[60:63], v[80:83], v[228:231], v[60:63]
    ds_read_b64_tr_b16 v[72:73], v11 offset:10240
    ds_read_b64_tr_b16 v[74:75], v11 offset:11520
    s_waitcnt lgkmcnt(10)
    v_mfma_f32_16x16x32_bf16 v[24:27], v[84:87], v[232:235], v[24:27]
    v_mfma_f32_16x16x32_bf16 v[28:31], v[84:87], v[236:239], v[28:31]
    ds_read_b64_tr_b16 v[76:77], v11 offset:10248
    ds_read_b64_tr_b16 v[78:79], v11 offset:11528
    s_waitcnt lgkmcnt(10)
    v_mfma_f32_16x16x32_bf16 v[32:35], v[88:91], v[232:235], v[32:35]
    v_mfma_f32_16x16x32_bf16 v[36:39], v[88:91], v[236:239], v[36:39]
    ds_read_b64_tr_b16 v[80:81], v12 offset:10240
    ds_read_b64_tr_b16 v[82:83], v12 offset:11520
    s_waitcnt lgkmcnt(10)
    v_mfma_f32_16x16x32_bf16 v[40:43], v[92:95], v[232:235], v[40:43]
    v_mfma_f32_16x16x32_bf16 v[44:47], v[92:95], v[236:239], v[44:47]
    ds_read_b64_tr_b16 v[84:85], v13 offset:10240
    ds_read_b64_tr_b16 v[86:87], v13 offset:11520
    s_waitcnt lgkmcnt(10)
    v_mfma_f32_16x16x32_bf16 v[48:51], v[64:67], v[232:235], v[48:51]
    v_mfma_f32_16x16x32_bf16 v[52:55], v[64:67], v[236:239], v[52:55]
    ds_read_b64_tr_b16 v[88:89], v13 offset:10248
    ds_read_b64_tr_b16 v[90:91], v13 offset:11528
    s_waitcnt lgkmcnt(10)
    v_mfma_f32_16x16x32_bf16 v[56:59], v[68:71], v[232:235], v[56:59]
    v_mfma_f32_16x16x32_bf16 v[60:63], v[68:71], v[236:239], v[60:63]
    ds_read_b64_tr_b16 v[92:93], v11 offset:15360
    ds_read_b64_tr_b16 v[94:95], v11 offset:16640
    s_waitcnt lgkmcnt(10)
    v_mfma_f32_16x16x32_bf16 v[24:27], v[72:75], v[240:243], v[24:27]
    v_mfma_f32_16x16x32_bf16 v[28:31], v[72:75], v[244:247], v[28:31]
    s_barrier
    s_sub_u32 s57, s40, 10
    s_cmp_ge_u32 s40, 10
    s_cselect_b32 s40, s57, s40
    s_mul_i32 s57, s40, 245760
    s_add_u32 s57, s57, s39
    s_add_u32 s40, s40, 2
    s_add_u32 m0, s38, 43520
    s_nop 0
    buffer_load_dwordx4 v14, s[12:15], s57 offen lds
    v_and_b32 v21, 8, v2
    v_and_b32 v22, 3, v2
    ds_read_b64_tr_b16 v[64:65], v11 offset:15368
    ds_read_b64_tr_b16 v[66:67], v11 offset:16648
    s_waitcnt lgkmcnt(10)
    v_mfma_f32_16x16x32_bf16 v[32:35], v[76:79], v[240:243], v[32:35]
    v_mfma_f32_16x16x32_bf16 v[36:39], v[76:79], v[244:247], v[36:39]
    s_add_u32 m0, s38, 44544
    s_nop 0
    buffer_load_dwordx4 v15, s[12:15], s57 offen lds
    v_lshl_or_b32 v21, v22, 1, v21
    v_bfe_u32 v22, v2, 2, 1
    ds_read_b64_tr_b16 v[68:69], v12 offset:15360
    ds_read_b64_tr_b16 v[70:71], v12 offset:16640
    s_waitcnt lgkmcnt(10)
    v_mfma_f32_16x16x32_bf16 v[40:43], v[80:83], v[240:243], v[40:43]
    v_mfma_f32_16x16x32_bf16 v[44:47], v[80:83], v[244:247], v[44:47]
    s_mov_b32 exec_hi, 0
    s_add_u32 m0, s38, 45568
    s_nop 0
    buffer_load_dwordx4 v16, s[12:15], s57 offen lds
    s_mov_b32 exec_hi, -1
    v_or_b32 v21, v21, v22
    s_lshl_b32 s55, s3, 5
    v_add_u32 v21, s55, v21
    ds_read_b64_tr_b16 v[72:73], v13 offset:15360
    ds_read_b64_tr_b16 v[74:75], v13 offset:16640
    s_waitcnt lgkmcnt(10)
    v_mfma_f32_16x16x32_bf16 v[48:51], v[84:87], v[240:243], v[48:51]
    v_mfma_f32_16x16x32_bf16 v[52:55], v[84:87], v[244:247], v[52:55]
    s_sub_u32 s57, s40, 10
    s_cmp_ge_u32 s40, 10
    s_cselect_b32 s40, s57, s40
    s_mul_i32 s57, s40, 245760
    s_add_u32 s57, s57, s39
    s_add_u32 s40, s40, 2
    s_add_u32 m0, s38, 53760
    s_nop 0
    buffer_load_dwordx4 v14, s[12:15], s57 offen lds
    v_mul_u32_u24 v21, 240, v21
    v_add_u32 v21, 2560, v21
    ds_read_b64_tr_b16 v[76:77], v13 offset:15368
    ds_read_b64_tr_b16 v[78:79], v13 offset:16648
    s_waitcnt lgkmcnt(10)
    v_mfma_f32_16x16x32_bf16 v[56:59], v[88:91], v[240:243], v[56:59]
    v_mfma_f32_16x16x32_bf16 v[60:63], v[88:91], v[244:247], v[60:63]
    s_add_u32 m0, s38, 54784
    s_nop 0
    buffer_load_dwordx4 v15, s[12:15], s57 offen lds
    v_lshrrev_b32 v22, 1, v3
    v_mul_u32_u24 v22, 120, v22
    s_waitcnt lgkmcnt(8)
    v_mfma_f32_16x16x32_bf16 v[24:27], v[92:95], v[248:251], v[24:27]
    v_mfma_f32_16x16x32_bf16 v[28:31], v[92:95], v[252:255], v[28:31]
    s_mov_b32 exec_hi, 0
    s_add_u32 m0, s38, 55808
    s_nop 0
    buffer_load_dwordx4 v16, s[12:15], s57 offen lds
    s_mov_b32 exec_hi, -1
    v_add_u32 v21, v21, v22
    v_and_b32 v22, 1, v3
    s_waitcnt lgkmcnt(6)
    v_mfma_f32_16x16x32_bf16 v[32:35], v[64:67], v[248:251], v[32:35]
    v_mfma_f32_16x16x32_bf16 v[36:39], v[64:67], v[252:255], v[36:39]
    s_sub_u32 s57, s40, 10
    s_cmp_ge_u32 s40, 10
    s_cselect_b32 s40, s57, s40
    s_mul_i32 s57, s40, 245760
    s_add_u32 s57, s57, s39
    s_add_u32 s40, s40, 2
    s_add_u32 m0, s38, 64000
    s_nop 0
    buffer_load_dwordx4 v14, s[12:15], s57 offen lds
    v_mul_u32_u24 v23, 40, v22
    v_add_u32 v6, v21, v23
    s_waitcnt lgkmcnt(4)
    v_mfma_f32_16x16x32_bf16 v[40:43], v[68:71], v[248:251], v[40:43]
    v_mfma_f32_16x16x32_bf16 v[44:47], v[68:71], v[252:255], v[44:47]
    s_add_u32 m0, s38, 65024
    s_nop 0
    buffer_load_dwordx4 v15, s[12:15], s57 offen lds
    v_mul_u32_u24 v23, 24, v22
    v_add_u32 v7, v21, v23
    s_waitcnt lgkmcnt(2)
    v_mfma_f32_16x16x32_bf16 v[48:51], v[72:75], v[248:251], v[48:51]
    v_mfma_f32_16x16x32_bf16 v[52:55], v[72:75], v[252:255], v[52:55]
    s_mov_b32 exec_hi, 0
    s_add_u32 m0, s38, 66048
    s_nop 0
    buffer_load_dwordx4 v16, s[12:15], s57 offen lds
    s_mov_b32 exec_hi, -1
    v_add_u32 v7, 80, v7
    v_add_u32 v5, 96, v21
    s_waitcnt lgkmcnt(0)
    v_mfma_f32_16x16x32_bf16 v[56:59], v[76:79], v[248:251], v[56:59]
    v_mfma_f32_16x16x32_bf16 v[60:63], v[76:79], v[252:255], v[60:63]
    s_setprio 2
    s_barrier
    s_lshl_b32 s52, s5, 4
    s_add_u32 s52, s52, s4
    s_lshl_b32 s53, s52, 6
    s_add_u32 s42, s53, 65536
    s_lshl_b32 s52, s52, 12
    s_lshl_b32 s53, s3, 10
    s_add_u32 s52, s52, s53
    s_add_u32 s52, s52, 6815744
    ds_read_b64_tr_b16 v[64:65], v19 offset:0
    ds_read_b64_tr_b16 v[66:67], v19 offset:192
    ds_read_b64_tr_b16 v[68:69], v20 offset:0
    ds_read_b64_tr_b16 v[72:73], v19 offset:16
    ds_read_b64_tr_b16 v[74:75], v19 offset:208
    ds_read_b64_tr_b16 v[76:77], v20 offset:16
    ds_read_b64_tr_b16 v[80:81], v19 offset:32
    ds_read_b64_tr_b16 v[82:83], v19 offset:224
    ds_read_b64_tr_b16 v[84:85], v20 offset:32
    v_mov_b32 v70, 0
    v_mov_b32 v71, 0
    v_mov_b32 v78, 0
    v_mov_b32 v79, 0
    v_mov_b32 v86, 0
    v_mov_b32 v87, 0
    v_cvt_pk_bf16_f32 v24, v24, v25
    v_cvt_pk_bf16_f32 v25, v26, v27
    v_cvt_pk_bf16_f32 v26, v32, v33
    v_cvt_pk_bf16_f32 v27, v34, v35
    v_cvt_pk_bf16_f32 v32, v40, v41
    v_cvt_pk_bf16_f32 v33, v42, v43
    v_mov_b32 v34, 0
    v_mov_b32 v35, 0
    v_cvt_pk_bf16_f32 v40, v48, v49
    v_cvt_pk_bf16_f32 v41, v50, v51
    v_cvt_pk_bf16_f32 v42, v56, v57
    v_cvt_pk_bf16_f32 v43, v58, v59
    v_cvt_pk_bf16_f32 v28, v28, v29
    v_cvt_pk_bf16_f32 v29, v30, v31
    v_cvt_pk_bf16_f32 v30, v36, v37
    v_cvt_pk_bf16_f32 v31, v38, v39
    v_cvt_pk_bf16_f32 v36, v44, v45
    v_cvt_pk_bf16_f32 v37, v46, v47
    v_mov_b32 v38, 0
    v_mov_b32 v39, 0
    v_cvt_pk_bf16_f32 v44, v52, v53
    v_cvt_pk_bf16_f32 v45, v54, v55
    v_cvt_pk_bf16_f32 v46, v60, v61
    v_cvt_pk_bf16_f32 v47, v62, v63
    s_waitcnt lgkmcnt(0)
    v_mfma_f32_16x16x32_bf16 v[48:51], v[64:67], v[24:27], 0
    v_mfma_f32_16x16x32_bf16 v[56:59], v[72:75], v[24:27], 0
    v_mfma_f32_16x16x32_bf16 v[88:91], v[80:83], v[24:27], 0
    v_mfma_f32_16x16x32_bf16 v[48:51], v[68:71], v[32:35], v[48:51]
    v_mfma_f32_16x16x32_bf16 v[56:59], v[76:79], v[32:35], v[56:59]
    v_mfma_f32_16x16x32_bf16 v[88:91], v[84:87], v[32:35], v[88:91]
    v_mfma_f32_16x16x32_bf16 v[52:55], v[64:67], v[28:31], 0
    v_mfma_f32_16x16x32_bf16 v[60:63], v[72:75], v[28:31], 0
    v_mfma_f32_16x16x32_bf16 v[92:95], v[80:83], v[28:31], 0
    v_mfma_f32_16x16x32_bf16 v[52:55], v[68:71], v[36:39], v[52:55]
    v_mfma_f32_16x16x32_bf16 v[60:63], v[76:79], v[36:39], v[60:63]
    v_mfma_f32_16x16x32_bf16 v[92:95], v[84:87], v[36:39], v[92:95]
    ds_write_b64 v7, v[40:41] offset:0
    ds_write_b64 v7, v[42:43] offset:8
    ds_write_b64 v7, v[44:45] offset:3840
    ds_write_b64 v7, v[46:47] offset:3848
    s_mov_b32 exec_lo, 0xffff0000
    s_mov_b32 exec_hi, 0xffff0000
    ds_write_b64 v5, v[32:33] offset:0
    ds_write_b64 v5, v[36:37] offset:3840
    s_mov_b64 exec, -1
    v_max3_f32 v8, v48, v49, v50
    v_min3_f32 v10, v48, v49, v50
    v_max3_f32 v8, v8, v51, v56
    v_min3_f32 v10, v10, v51, v56
    v_max3_f32 v8, v8, v57, v58
    v_min3_f32 v10, v10, v57, v58
    v_max3_f32 v8, v8, v59, v88
    v_min3_f32 v10, v10, v59, v88
    v_max_f32 v8, v8, v89
    v_min_f32 v10, v10, v89
    v_mov_b32 v9, v8
    v_mov_b32 v11, v10
    s_nop 0
    v_permlane16_swap_b32 v8, v9
    v_permlane16_swap_b32 v10, v11
    v_max_f32 v8, v8, v9
    v_min_f32 v10, v10, v11
    v_mul_f32 v8, s22, v8
    v_mul_f32 v10, s22, v10
    v_pk_fma_f32 v[24:25], v[48:49], s[22:23], v[8:9] op_sel_hi:[1,1,0] neg_lo:[0,0,1] neg_hi:[0,0,1]
    v_pk_fma_f32 v[48:49], v[48:49], s[22:23], v[10:11] op_sel_hi:[1,1,0] neg_lo:[1,0,0] neg_hi:[1,0,0]
    v_pk_fma_f32 v[26:27], v[50:51], s[22:23], v[8:9] op_sel_hi:[1,1,0] neg_lo:[0,0,1] neg_hi:[0,0,1]
    v_pk_fma_f32 v[50:51], v[50:51], s[22:23], v[10:11] op_sel_hi:[1,1,0] neg_lo:[1,0,0] neg_hi:[1,0,0]
    v_pk_fma_f32 v[32:33], v[56:57], s[22:23], v[8:9] op_sel_hi:[1,1,0] neg_lo:[0,0,1] neg_hi:[0,0,1]
    v_pk_fma_f32 v[56:57], v[56:57], s[22:23], v[10:11] op_sel_hi:[1,1,0] neg_lo:[1,0,0] neg_hi:[1,0,0]
    v_pk_fma_f32 v[34:35], v[58:59], s[22:23], v[8:9] op_sel_hi:[1,1,0] neg_lo:[0,0,1] neg_hi:[0,0,1]
    v_pk_fma_f32 v[58:59], v[58:59], s[22:23], v[10:11] op_sel_hi:[1,1,0] neg_lo:[1,0,0] neg_hi:[1,0,0]
    v_pk_fma_f32 v[40:41], v[88:89], s[22:23], v[8:9] op_sel_hi:[1,1,0] neg_lo:[0,0,1] neg_hi:[0,0,1]
    v_pk_fma_f32 v[88:89], v[88:89], s[22:23], v[10:11] op_sel_hi:[1,1,0] neg_lo:[1,0,0] neg_hi:[1,0,0]
    v_exp_f32 v24, v24
    v_exp_f32 v48, v48
    v_exp_f32 v25, v25
    v_exp_f32 v49, v49
    v_exp_f32 v26, v26
    v_exp_f32 v50, v50
    v_exp_f32 v27, v27
    v_exp_f32 v51, v51
    v_exp_f32 v32, v32
    v_exp_f32 v56, v56
    v_exp_f32 v33, v33
    v_exp_f32 v57, v57
    v_exp_f32 v34, v34
    v_exp_f32 v58, v58
    v_exp_f32 v35, v35
    v_exp_f32 v59, v59
    v_exp_f32 v40, v40
    v_exp_f32 v88, v88
    v_exp_f32 v41, v41
    v_exp_f32 v89, v89
    v_pk_add_f32 v[12:13], v[24:25], v[26:27]
    v_pk_add_f32 v[22:23], v[48:49], v[50:51]
    v_pk_add_f32 v[12:13], v[12:13], v[32:33]
    v_pk_add_f32 v[22:23], v[22:23], v[56:57]
    v_pk_add_f32 v[12:13], v[12:13], v[34:35]
    v_pk_add_f32 v[22:23], v[22:23], v[58:59]
    v_pk_add_f32 v[12:13], v[12:13], v[40:41]
    v_pk_add_f32 v[22:23], v[22:23], v[88:89]
    v_add_f32 v12, v12, v13
    v_add_f32 v22, v22, v23
    v_mov_b32 v13, v12
    v_mov_b32 v23, v22
    s_nop 0
    v_permlane16_swap_b32 v12, v13
    v_permlane16_swap_b32 v22, v23
    v_add_f32 v12, v12, v13
    v_add_f32 v22, v22, v23
    v_rcp_f32 v12, v12
    v_rcp_f32 v22, v22
    v_pk_mul_f32 v[24:25], v[24:25], v[12:13] op_sel_hi:[1,0]
    v_pk_mul_f32 v[48:49], v[48:49], v[22:23] op_sel_hi:[1,0]
    v_pk_mul_f32 v[26:27], v[26:27], v[12:13] op_sel_hi:[1,0]
    v_pk_mul_f32 v[50:51], v[50:51], v[22:23] op_sel_hi:[1,0]
    v_pk_mul_f32 v[32:33], v[32:33], v[12:13] op_sel_hi:[1,0]
    v_pk_mul_f32 v[56:57], v[56:57], v[22:23] op_sel_hi:[1,0]
    v_pk_mul_f32 v[34:35], v[34:35], v[12:13] op_sel_hi:[1,0]
    v_pk_mul_f32 v[58:59], v[58:59], v[22:23] op_sel_hi:[1,0]
    v_pk_mul_f32 v[40:41], v[40:41], v[12:13] op_sel_hi:[1,0]
    v_pk_mul_f32 v[88:89], v[88:89], v[22:23] op_sel_hi:[1,0]
    v_cvt_pk_bf16_f32 v24, v24, v25
    v_cvt_pk_bf16_f32 v25, v26, v27
    v_cvt_pk_bf16_f32 v26, v32, v33
    v_cvt_pk_bf16_f32 v27, v34, v35
    v_cvt_pk_bf16_f32 v32, v40, v41
    v_cvt_pk_bf16_f32 v33, v48, v49
    v_cvt_pk_bf16_f32 v34, v50, v51
    v_cvt_pk_bf16_f32 v35, v56, v57
    v_cvt_pk_bf16_f32 v40, v58, v59
    v_cvt_pk_bf16_f32 v41, v88, v89
    ds_write_b64 v6, v[24:25] offset:0
    ds_write_b64 v6, v[26:27] offset:8
    ds_write_b64 v6, v[32:33] offset:16
    ds_write_b64 v6, v[34:35] offset:24
    ds_write_b64 v6, v[40:41] offset:32
    v_max3_f32 v8, v52, v53, v54
    v_min3_f32 v10, v52, v53, v54
    v_max3_f32 v8, v8, v55, v60
    v_min3_f32 v10, v10, v55, v60
    v_max3_f32 v8, v8, v61, v62
    v_min3_f32 v10, v10, v61, v62
    v_max3_f32 v8, v8, v63, v92
    v_min3_f32 v10, v10, v63, v92
    v_max_f32 v8, v8, v93
    v_min_f32 v10, v10, v93
    v_mov_b32 v9, v8
    v_mov_b32 v11, v10
    s_nop 0
    v_permlane16_swap_b32 v8, v9
    v_permlane16_swap_b32 v10, v11
    v_max_f32 v8, v8, v9
    v_min_f32 v10, v10, v11
    v_mul_f32 v8, s22, v8
    v_mul_f32 v10, s22, v10
    v_pk_fma_f32 v[28:29], v[52:53], s[22:23], v[8:9] op_sel_hi:[1,1,0] neg_lo:[0,0,1] neg_hi:[0,0,1]
    v_pk_fma_f32 v[52:53], v[52:53], s[22:23], v[10:11] op_sel_hi:[1,1,0] neg_lo:[1,0,0] neg_hi:[1,0,0]
    v_pk_fma_f32 v[30:31], v[54:55], s[22:23], v[8:9] op_sel_hi:[1,1,0] neg_lo:[0,0,1] neg_hi:[0,0,1]
    v_pk_fma_f32 v[54:55], v[54:55], s[22:23], v[10:11] op_sel_hi:[1,1,0] neg_lo:[1,0,0] neg_hi:[1,0,0]
    v_pk_fma_f32 v[36:37], v[60:61], s[22:23], v[8:9] op_sel_hi:[1,1,0] neg_lo:[0,0,1] neg_hi:[0,0,1]
    v_pk_fma_f32 v[60:61], v[60:61], s[22:23], v[10:11] op_sel_hi:[1,1,0] neg_lo:[1,0,0] neg_hi:[1,0,0]
    v_pk_fma_f32 v[38:39], v[62:63], s[22:23], v[8:9] op_sel_hi:[1,1,0] neg_lo:[0,0,1] neg_hi:[0,0,1]
    v_pk_fma_f32 v[62:63], v[62:63], s[22:23], v[10:11] op_sel_hi:[1,1,0] neg_lo:[1,0,0] neg_hi:[1,0,0]
    v_pk_fma_f32 v[44:45], v[92:93], s[22:23], v[8:9] op_sel_hi:[1,1,0] neg_lo:[0,0,1] neg_hi:[0,0,1]
    v_pk_fma_f32 v[92:93], v[92:93], s[22:23], v[10:11] op_sel_hi:[1,1,0] neg_lo:[1,0,0] neg_hi:[1,0,0]
    v_exp_f32 v28, v28
    v_exp_f32 v52, v52
    v_exp_f32 v29, v29
    v_exp_f32 v53, v53
    v_exp_f32 v30, v30
    v_exp_f32 v54, v54
    v_exp_f32 v31, v31
    v_exp_f32 v55, v55
    v_exp_f32 v36, v36
    v_exp_f32 v60, v60
    v_exp_f32 v37, v37
    v_exp_f32 v61, v61
    v_exp_f32 v38, v38
    v_exp_f32 v62, v62
    v_exp_f32 v39, v39
    v_exp_f32 v63, v63
    v_exp_f32 v44, v44
    v_exp_f32 v92, v92
    v_exp_f32 v45, v45
    v_exp_f32 v93, v93
    v_pk_add_f32 v[12:13], v[28:29], v[30:31]
    v_pk_add_f32 v[22:23], v[52:53], v[54:55]
    v_pk_add_f32 v[12:13], v[12:13], v[36:37]
    v_pk_add_f32 v[22:23], v[22:23], v[60:61]
    v_pk_add_f32 v[12:13], v[12:13], v[38:39]
    v_pk_add_f32 v[22:23], v[22:23], v[62:63]
    v_pk_add_f32 v[12:13], v[12:13], v[44:45]
    v_pk_add_f32 v[22:23], v[22:23], v[92:93]
    v_add_f32 v12, v12, v13
    v_add_f32 v22, v22, v23
    v_mov_b32 v13, v12
    v_mov_b32 v23, v22
    s_nop 0
    v_permlane16_swap_b32 v12, v13
    v_permlane16_swap_b32 v22, v23
    v_add_f32 v12, v12, v13
    v_add_f32 v22, v22, v23
    v_rcp_f32 v12, v12
    v_rcp_f32 v22, v22
    v_pk_mul_f32 v[28:29], v[28:29], v[12:13] op_sel_hi:[1,0]
    v_pk_mul_f32 v[52:53], v[52:53], v[22:23] op_sel_hi:[1,0]
    v_pk_mul_f32 v[30:31], v[30:31], v[12:13] op_sel_hi:[1,0]
    v_pk_mul_f32 v[54:55], v[54:55], v[22:23] op_sel_hi:[1,0]
    v_pk_mul_f32 v[36:37], v[36:37], v[12:13] op_sel_hi:[1,0]
    v_pk_mul_f32 v[60:61], v[60:61], v[22:23] op_sel_hi:[1,0]
    v_pk_mul_f32 v[38:39], v[38:39], v[12:13] op_sel_hi:[1,0]
    v_pk_mul_f32 v[62:63], v[62:63], v[22:23] op_sel_hi:[1,0]
    v_pk_mul_f32 v[44:45], v[44:45], v[12:13] op_sel_hi:[1,0]
    v_pk_mul_f32 v[92:93], v[92:93], v[22:23] op_sel_hi:[1,0]
    v_cvt_pk_bf16_f32 v28, v28, v29
    v_cvt_pk_bf16_f32 v29, v30, v31
    v_cvt_pk_bf16_f32 v30, v36, v37
    v_cvt_pk_bf16_f32 v31, v38, v39
    v_cvt_pk_bf16_f32 v36, v44, v45
    v_cvt_pk_bf16_f32 v37, v52, v53
    v_cvt_pk_bf16_f32 v38, v54, v55
    v_cvt_pk_bf16_f32 v39, v60, v61
    v_cvt_pk_bf16_f32 v44, v62, v63
    v_cvt_pk_bf16_f32 v45, v92, v93
    ds_write_b64 v6, v[28:29] offset:3840
    ds_write_b64 v6, v[30:31] offset:3848
    ds_write_b64 v6, v[36:37] offset:3856
    ds_write_b64 v6, v[38:39] offset:3864
    ds_write_b64 v6, v[44:45] offset:3872
    s_waitcnt lgkmcnt(0)
    s_barrier
    v_lshrrev_b32 v21, 2, v2
    v_and_b32 v23, 1, v3
    v_lshl_add_u32 v23, v23, 2, v21
    v_lshlrev_b32 v23, 1, v23
    v_lshrrev_b32 v21, 1, v3
    v_lshl_add_u32 v23, v21, 4, v23
    v_mul_u32_u24 v4, 240, v23
    v_add_u32 v4, 2560, v4
    s_lshr_b32 s50, s3, 1
    s_and_b32 s51, s3, 1
    s_mul_i32 s52, s50, 120
    v_and_b32 v22, 3, v1
    v_lshlrev_b32 v22, 3, v22
    v_add_u32 v6, s52, v4
    v_add_u32 v7, 80, v6
    v_add_u32 v6, v6, v22
    s_cmp_eq_u32 s51, 0
    s_cselect_b64 s[52:53], -1, 0
    v_mov_b32 v23, 32
    v_cndmask_b32 v22, v23, v22, s[52:53]
    v_add_u32 v7, v7, v22
    v_cmp_eq_u32 s[58:59], 4, v2
    v_mov_b32 v21, 0x3f803f80
    s_andn2_b64 s[58:59], s[58:59], s[52:53]
    ds_read_b64_tr_b16 v[64:65], v6 offset:0
    ds_read_b64_tr_b16 v[66:67], v6 offset:240
    ds_read_b64_tr_b16 v[68:69], v6 offset:32
    ds_read_b64_tr_b16 v[70:71], v6 offset:272
    ds_read_b64_tr_b16 v[72:73], v6 offset:64
    ds_read_b64_tr_b16 v[74:75], v6 offset:304
    ds_read_b64_tr_b16 v[76:77], v7 offset:0
    ds_read_b64_tr_b16 v[78:79], v7 offset:240
    ds_read_b64_tr_b16 v[80:81], v6 offset:7680
    ds_read_b64_tr_b16 v[82:83], v6 offset:7920
    ds_read_b64_tr_b16 v[84:85], v6 offset:7712
    ds_read_b64_tr_b16 v[86:87], v6 offset:7952
    ds_read_b64_tr_b16 v[88:89], v6 offset:7744
    ds_read_b64_tr_b16 v[90:91], v6 offset:7984
    ds_read_b64_tr_b16 v[92:93], v7 offset:7680
    ds_read_b64_tr_b16 v[94:95], v7 offset:7920
    s_waitcnt lgkmcnt(8)
    v_cndmask_b32 v76, v76, v21, s[58:59]
    v_cndmask_b32 v77, v77, v21, s[58:59]
    v_cndmask_b32 v78, v78, v21, s[58:59]
    v_cndmask_b32 v79, v79, v21, s[58:59]
    s_nop 1
    v_mfma_f32_16x16x32_bf16 v[24:27], v[64:67], v[76:79], 0
    v_mfma_f32_16x16x32_bf16 v[32:35], v[68:71], v[76:79], 0
    v_mfma_f32_16x16x32_bf16 v[40:43], v[72:75], v[76:79], 0
    ds_read_b64_tr_b16 v[64:65], v6 offset:15360
    ds_read_b64_tr_b16 v[66:67], v6 offset:15600
    ds_read_b64_tr_b16 v[68:69], v6 offset:15392
    ds_read_b64_tr_b16 v[70:71], v6 offset:15632
    ds_read_b64_tr_b16 v[72:73], v6 offset:15424
    ds_read_b64_tr_b16 v[74:75], v6 offset:15664
    ds_read_b64_tr_b16 v[76:77], v7 offset:15360
    ds_read_b64_tr_b16 v[78:79], v7 offset:15600
    s_waitcnt lgkmcnt(8)
    v_cndmask_b32 v92, v92, v21, s[58:59]
    v_cndmask_b32 v93, v93, v21, s[58:59]
    v_cndmask_b32 v94, v94, v21, s[58:59]
    v_cndmask_b32 v95, v95, v21, s[58:59]
    s_nop 1
    v_mfma_f32_16x16x32_bf16 v[24:27], v[80:83], v[92:95], v[24:27]
    v_mfma_f32_16x16x32_bf16 v[32:35], v[84:87], v[92:95], v[32:35]
    v_mfma_f32_16x16x32_bf16 v[40:43], v[88:91], v[92:95], v[40:43]
    ds_read_b64_tr_b16 v[80:81], v6 offset:23040
    ds_read_b64_tr_b16 v[82:83], v6 offset:23280
    ds_read_b64_tr_b16 v[84:85], v6 offset:23072
    ds_read_b64_tr_b16 v[86:87], v6 offset:23312
    ds_read_b64_tr_b16 v[88:89], v6 offset:23104
    ds_read_b64_tr_b16 v[90:91], v6 offset:23344
    ds_read_b64_tr_b16 v[92:93], v7 offset:23040
    ds_read_b64_tr_b16 v[94:95], v7 offset:23280
    s_waitcnt lgkmcnt(8)
    v_cndmask_b32 v76, v76, v21, s[58:59]
    v_cndmask_b32 v77, v77, v21, s[58:59]
    v_cndmask_b32 v78, v78, v21, s[58:59]
    v_cndmask_b32 v79, v79, v21, s[58:59]
    s_nop 1
    v_mfma_f32_16x16x32_bf16 v[24:27], v[64:67], v[76:79], v[24:27]
    v_mfma_f32_16x16x32_bf16 v[32:35], v[68:71], v[76:79], v[32:35]
    v_mfma_f32_16x16x32_bf16 v[40:43], v[72:75], v[76:79], v[40:43]
    s_waitcnt lgkmcnt(0)
    v_cndmask_b32 v92, v92, v21, s[58:59]
    v_cndmask_b32 v93, v93, v21, s[58:59]
    v_cndmask_b32 v94, v94, v21, s[58:59]
    v_cndmask_b32 v95, v95, v21, s[58:59]
    s_nop 1
    v_mfma_f32_16x16x32_bf16 v[24:27], v[80:83], v[92:95], v[24:27]
    v_mfma_f32_16x16x32_bf16 v[32:35], v[84:87], v[92:95], v[32:35]
    v_mfma_f32_16x16x32_bf16 v[40:43], v[88:91], v[92:95], v[40:43]
    s_waitcnt vmcnt(0)
    s_barrier
    s_mul_i32 s52, s50, 2016
    s_mul_i32 s53, s51, 1536
    s_add_u32 s52, s52, s53
    v_mul_u32_u24 v22, 96, v2
    v_add_u32 v22, s52, v22
    v_lshlrev_b32 v23, 3, v3
    s_mov_b32 s53, 403703808
    v_bfe_u32 v5, s53, v23, 8
    v_add_u32 v5, v5, v22
    s_mov_b32 s53, 1077424160
    v_bfe_u32 v8, s53, v23, 8
    v_add_u32 v8, v8, v22
    s_mov_b32 s53, 1479037000
    v_bfe_u32 v9, s53, v23, 8
    v_add_u32 v9, v9, v22
    s_lshl_b32 s52, s5, 4
    s_add_u32 s52, s52, s4
    s_mul_i32 s52, s52, 4096
    s_add_u32 s52, s52, 6815744
    v_cmp_ge_u32 vcc, 4, v2
    s_cmp_eq_u32 s51, 0
    s_cselect_b64 s[58:59], -1, vcc
    v_cmp_gt_u32 vcc, 32, v1
    v_cvt_pk_bf16_f32 v24, v24, v25
    v_cvt_pk_bf16_f32 v25, v26, v27
    v_cvt_pk_bf16_f32 v32, v32, v33
    v_cvt_pk_bf16_f32 v33, v34, v35
    v_cvt_pk_bf16_f32 v40, v40, v41
    v_cvt_pk_bf16_f32 v41, v42, v43
    v_cndmask_b32 v40, 0, v40, vcc
    v_cndmask_b32 v41, 0, v41, vcc
    s_mov_b64 exec, s[58:59]
    buffer_store_dwordx2 v[24:25], v5, s[60:63], s52 offen sc1
    buffer_store_dwordx2 v[32:33], v8, s[60:63], s52 offen sc1
    buffer_store_dwordx2 v[40:41], v9, s[60:63], s52 offen sc1
    s_mov_b64 exec, -1
    s_sub_u32 s57, s40, 10
    s_cmp_ge_u32 s40, 10
    s_cselect_b32 s40, s57, s40
    s_mul_i32 s57, s40, 245760
    s_add_u32 s57, s57, s39
    s_add_u32 s40, s40, 2
    s_add_u32 m0, s38, 2560
    s_nop 0
    buffer_load_dwordx4 v14, s[12:15], s57 offen lds
    s_add_u32 m0, s38, 3584
    s_nop 0
    buffer_load_dwordx4 v15, s[12:15], s57 offen lds
    s_mov_b32 exec_hi, 0
    s_add_u32 m0, s38, 4608
    s_nop 0
    buffer_load_dwordx4 v16, s[12:15], s57 offen lds
    s_mov_b32 exec_hi, -1
    s_mul_i32 s54, s4, 163840
    s_mul_i32 s55, s3, 40960
    s_add_u32 s54, s54, s55
    s_mul_i32 s55, s5, 1280
    s_add_u32 s54, s54, s55
    s_add_u32 s31, s54, 8388608
    s_lshl_b32 s52, s4, 2
    s_add_u32 s52, s52, s3
    s_lshl_b32 s52, s52, 4
    s_add_u32 s52, s52, s5
    s_lshl_b32 s52, s52, 6
    s_add_u32 s29, s52, 163840
    v_lshlrev_b32 v15, 4, v1
    v_cmp_le_u32 vcc, 16, v1
    v_add_u32 v16, 1024, v15
    v_add_u32 v21, 20224, v15
    v_cndmask_b32 v16, v16, v21, vcc
    ds_read_b64_tr_b16 v[64:65], v17 offset:0
    ds_read_b64_tr_b16 v[66:67], v17 offset:80
    ds_read_b64_tr_b16 v[68:69], v17 offset:8
    ds_read_b64_tr_b16 v[70:71], v17 offset:88
    ds_read_b64_tr_b16 v[72:73], v18 offset:0
    ds_read_b64_tr_b16 v[74:75], v18 offset:80
    ds_read_b64_tr_b16 v[76:77], v17 offset:2560
    ds_read_b64_tr_b16 v[78:79], v17 offset:2640
    ds_read_b64_tr_b16 v[80:81], v17 offset:2568
    ds_read_b64_tr_b16 v[82:83], v17 offset:2648
    ds_read_b64_tr_b16 v[84:85], v18 offset:2560
    ds_read_b64_tr_b16 v[86:87], v18 offset:2640
    s_waitcnt lgkmcnt(10)
    v_mfma_f32_16x16x32_bf16 v[24:27], v[64:67], v[96:99], 0
    v_mfma_f32_16x16x32_bf16 v[28:31], v[64:67], v[100:103], 0
    ds_read_b64_tr_b16 v[88:89], v17 offset:5120
    ds_read_b64_tr_b16 v[90:91], v17 offset:5200
    s_waitcnt lgkmcnt(10)
    v_mfma_f32_16x16x32_bf16 v[32:35], v[68:71], v[96:99], 0
    v_mfma_f32_16x16x32_bf16 v[36:39], v[68:71], v[100:103], 0
    ds_read_b64_tr_b16 v[92:93], v17 offset:5128
    ds_read_b64_tr_b16 v[94:95], v17 offset:5208
    s_waitcnt lgkmcnt(10)
    v_mfma_f32_16x16x32_bf16 v[40:43], v[72:75], v[96:99], 0
    v_mfma_f32_16x16x32_bf16 v[44:47], v[72:75], v[100:103], 0
    ds_read_b64_tr_b16 v[64:65], v18 offset:5120
    ds_read_b64_tr_b16 v[66:67], v18 offset:5200
    s_waitcnt lgkmcnt(10)
    v_mfma_f32_16x16x32_bf16 v[24:27], v[76:79], v[104:107], v[24:27]
    v_mfma_f32_16x16x32_bf16 v[28:31], v[76:79], v[108:111], v[28:31]
    ds_read_b64_tr_b16 v[68:69], v17 offset:7680
    ds_read_b64_tr_b16 v[70:71], v17 offset:7760
    s_waitcnt lgkmcnt(10)
    v_mfma_f32_16x16x32_bf16 v[32:35], v[80:83], v[104:107], v[32:35]
    v_mfma_f32_16x16x32_bf16 v[36:39], v[80:83], v[108:111], v[36:39]
    ds_read_b64_tr_b16 v[72:73], v17 offset:7688
    ds_read_b64_tr_b16 v[74:75], v17 offset:7768
    s_waitcnt lgkmcnt(10)
    v_mfma_f32_16x16x32_bf16 v[40:43], v[84:87], v[104:107], v[40:43]
    v_mfma_f32_16x16x32_bf16 v[44:47], v[84:87], v[108:111], v[44:47]
    ds_read_b64_tr_b16 v[76:77], v18 offset:7680
    ds_read_b64_tr_b16 v[78:79], v18 offset:7760
    s_waitcnt lgkmcnt(10)
    v_mfma_f32_16x16x32_bf16 v[24:27], v[88:91], v[112:115], v[24:27]
    v_mfma_f32_16x16x32_bf16 v[28:31], v[88:91], v[116:119], v[28:31]
    ds_read_b64_tr_b16 v[80:81], v17 offset:10240
    ds_read_b64_tr_b16 v[82:83], v17 offset:10320
    s_waitcnt lgkmcnt(10)
    v_mfma_f32_16x16x32_bf16 v[32:35], v[92:95], v[112:115], v[32:35]
    v_mfma_f32_16x16x32_bf16 v[36:39], v[92:95], v[116:119], v[36:39]
    ds_read_b64_tr_b16 v[84:85], v17 offset:10248
    ds_read_b64_tr_b16 v[86:87], v17 offset:10328
    s_waitcnt lgkmcnt(10)
    v_mfma_f32_16x16x32_bf16 v[40:43], v[64:67], v[112:115], v[40:43]
    v_mfma_f32_16x16x32_bf16 v[44:47], v[64:67], v[116:119], v[44:47]
    ds_read_b64_tr_b16 v[88:89], v18 offset:10240
    ds_read_b64_tr_b16 v[90:91], v18 offset:10320
    s_waitcnt lgkmcnt(10)
    v_mfma_f32_16x16x32_bf16 v[24:27], v[68:71], v[120:123], v[24:27]
    v_mfma_f32_16x16x32_bf16 v[28:31], v[68:71], v[124:127], v[28:31]
    ds_read_b64_tr_b16 v[92:93], v17 offset:12800
    ds_read_b64_tr_b16 v[94:95], v17 offset:12880
    s_waitcnt lgkmcnt(10)
    v_mfma_f32_16x16x32_bf16 v[32:35], v[72:75], v[120:123], v[32:35]
    v_mfma_f32_16x16x32_bf16 v[36:39], v[72:75], v[124:127], v[36:39]
    ds_read_b64_tr_b16 v[64:65], v17 offset:12808
    ds_read_b64_tr_b16 v[66:67], v17 offset:12888
    s_waitcnt lgkmcnt(10)
    v_mfma_f32_16x16x32_bf16 v[40:43], v[76:79], v[120:123], v[40:43]
    v_mfma_f32_16x16x32_bf16 v[44:47], v[76:79], v[124:127], v[44:47]
    ds_read_b64_tr_b16 v[68:69], v18 offset:12800
    ds_read_b64_tr_b16 v[70:71], v18 offset:12880
    s_waitcnt lgkmcnt(10)
    v_mfma_f32_16x16x32_bf16 v[24:27], v[80:83], v[128:131], v[24:27]
    v_mfma_f32_16x16x32_bf16 v[28:31], v[80:83], v[132:135], v[28:31]
    ds_read_b64_tr_b16 v[72:73], v17 offset:15360
    ds_read_b64_tr_b16 v[74:75], v17 offset:15440
    s_waitcnt lgkmcnt(10)
    v_mfma_f32_16x16x32_bf16 v[32:35], v[84:87], v[128:131], v[32:35]
    v_mfma_f32_16x16x32_bf16 v[36:39], v[84:87], v[132:135], v[36:39]
    ds_read_b64_tr_b16 v[76:77], v17 offset:15368
    ds_read_b64_tr_b16 v[78:79], v17 offset:15448
    s_waitcnt lgkmcnt(10)
    v_mfma_f32_16x16x32_bf16 v[40:43], v[88:91], v[128:131], v[40:43]
    v_mfma_f32_16x16x32_bf16 v[44:47], v[88:91], v[132:135], v[44:47]
    ds_read_b64_tr_b16 v[80:81], v18 offset:15360
    ds_read_b64_tr_b16 v[82:83], v18 offset:15440
    s_waitcnt lgkmcnt(10)
    v_mfma_f32_16x16x32_bf16 v[24:27], v[92:95], v[136:139], v[24:27]
    v_mfma_f32_16x16x32_bf16 v[28:31], v[92:95], v[140:143], v[28:31]
    ds_read_b64_tr_b16 v[84:85], v17 offset:17920
    ds_read_b64_tr_b16 v[86:87], v17 offset:18000
    s_waitcnt lgkmcnt(10)
    v_mfma_f32_16x16x32_bf16 v[32:35], v[64:67], v[136:139], v[32:35]
    v_mfma_f32_16x16x32_bf16 v[36:39], v[64:67], v[140:143], v[36:39]
    ds_read_b64_tr_b16 v[88:89], v17 offset:17928
    ds_read_b64_tr_b16 v[90:91], v17 offset:18008
    s_waitcnt lgkmcnt(10)
    v_mfma_f32_16x16x32_bf16 v[40:43], v[68:71], v[136:139], v[40:43]
    v_mfma_f32_16x16x32_bf16 v[44:47], v[68:71], v[140:143], v[44:47]
    ds_read_b64_tr_b16 v[92:93], v18 offset:17920
    ds_read_b64_tr_b16 v[94:95], v18 offset:18000
    s_waitcnt lgkmcnt(10)
    v_mfma_f32_16x16x32_bf16 v[24:27], v[72:75], v[144:147], v[24:27]
    v_mfma_f32_16x16x32_bf16 v[28:31], v[72:75], v[148:151], v[28:31]
    ds_read_b64_tr_b16 v[64:65], v17 offset:20480
    ds_read_b64_tr_b16 v[66:67], v17 offset:20560
    s_waitcnt lgkmcnt(10)
    v_mfma_f32_16x16x32_bf16 v[32:35], v[76:79], v[144:147], v[32:35]
    v_mfma_f32_16x16x32_bf16 v[36:39], v[76:79], v[148:151], v[36:39]
    s_waitcnt vmcnt(3)
    s_barrier
    s_cmp_lg_u32 s3, 0
    s_cbranch_scc1 L_nf1_1
    v_mov_b32 v21, s42
    v_mov_b32 v22, s24
    s_mov_b64 exec, 1
    global_store_dword v21, v22, s[16:17] sc1
    s_mov_b64 exec, -1
L_nf1_1:
    ds_read_b64_tr_b16 v[68:69], v17 offset:20488
    ds_read_b64_tr_b16 v[70:71], v17 offset:20568
    s_waitcnt lgkmcnt(10)
    v_mfma_f32_16x16x32_bf16 v[40:43], v[80:83], v[144:147], v[40:43]
    v_mfma_f32_16x16x32_bf16 v[44:47], v[80:83], v[148:151], v[44:47]
    ds_read_b64_tr_b16 v[72:73], v18 offset:20480
    ds_read_b64_tr_b16 v[74:75], v18 offset:20560
    s_waitcnt lgkmcnt(10)
    v_mfma_f32_16x16x32_bf16 v[24:27], v[84:87], v[152:155], v[24:27]
    v_mfma_f32_16x16x32_bf16 v[28:31], v[84:87], v[156:159], v[28:31]
    ds_read_b64_tr_b16 v[76:77], v17 offset:23040
    ds_read_b64_tr_b16 v[78:79], v17 offset:23120
    s_waitcnt lgkmcnt(10)
    v_mfma_f32_16x16x32_bf16 v[32:35], v[88:91], v[152:155], v[32:35]
    v_mfma_f32_16x16x32_bf16 v[36:39], v[88:91], v[156:159], v[36:39]
    ds_read_b64_tr_b16 v[80:81], v17 offset:23048
    ds_read_b64_tr_b16 v[82:83], v17 offset:23128
    s_waitcnt lgkmcnt(10)
    v_mfma_f32_16x16x32_bf16 v[40:43], v[92:95], v[152:155], v[40:43]
    v_mfma_f32_16x16x32_bf16 v[44:47], v[92:95], v[156:159], v[44:47]
    ds_read_b64_tr_b16 v[84:85], v18 offset:23040
    ds_read_b64_tr_b16 v[86:87], v18 offset:23120
    s_waitcnt lgkmcnt(10)
    v_mfma_f32_16x16x32_bf16 v[24:27], v[64:67], v[160:163], v[24:27]
    v_mfma_f32_16x16x32_bf16 v[28:31], v[64:67], v[164:167], v[28:31]
    ds_read_b64_tr_b16 v[88:89], v17 offset:25600
    ds_read_b64_tr_b16 v[90:91], v17 offset:25680
    s_waitcnt lgkmcnt(10)
    v_mfma_f32_16x16x32_bf16 v[32:35], v[68:71], v[160:163], v[32:35]
    v_mfma_f32_16x16x32_bf16 v[36:39], v[68:71], v[164:167], v[36:39]
    ds_read_b64_tr_b16 v[92:93], v17 offset:25608
    ds_read_b64_tr_b16 v[94:95], v17 offset:25688
    s_waitcnt lgkmcnt(10)
    v_mfma_f32_16x16x32_bf16 v[40:43], v[72:75], v[160:163], v[40:43]
    v_mfma_f32_16x16x32_bf16 v[44:47], v[72:75], v[164:167], v[44:47]
    ds_read_b64_tr_b16 v[64:65], v18 offset:25600
    ds_read_b64_tr_b16 v[66:67], v18 offset:25680
    s_waitcnt lgkmcnt(10)
    v_mfma_f32_16x16x32_bf16 v[24:27], v[76:79], v[168:171], v[24:27]
    v_mfma_f32_16x16x32_bf16 v[28:31], v[76:79], v[172:175], v[28:31]
    ds_read_b64_tr_b16 v[68:69], v17 offset:28160
    ds_read_b64_tr_b16 v[70:71], v17 offset:28240
    s_waitcnt lgkmcnt(10)
    v_mfma_f32_16x16x32_bf16 v[32:35], v[80:83], v[168:171], v[32:35]
    v_mfma_f32_16x16x32_bf16 v[36:39], v[80:83], v[172:175], v[36:39]
    ds_read_b64_tr_b16 v[72:73], v17 offset:28168
    ds_read_b64_tr_b16 v[74:75], v17 offset:28248
    s_waitcnt lgkmcnt(10)
    v_mfma_f32_16x16x32_bf16 v[40:43], v[84:87], v[168:171], v[40:43]
    v_mfma_f32_16x16x32_bf16 v[44:47], v[84:87], v[172:175], v[44:47]
    ds_read_b64_tr_b16 v[76:77], v18 offset:28160
    ds_read_b64_tr_b16 v[78:79], v18 offset:28240
    s_waitcnt lgkmcnt(10)
    v_mfma_f32_16x16x32_bf16 v[24:27], v[88:91], v[176:179], v[24:27]
    v_mfma_f32_16x16x32_bf16 v[28:31], v[88:91], v[180:183], v[28:31]
    ds_read_b64_tr_b16 v[80:81], v17 offset:30720
    ds_read_b64_tr_b16 v[82:83], v17 offset:30800
    s_waitcnt lgkmcnt(10)
    v_mfma_f32_16x16x32_bf16 v[32:35], v[92:95], v[176:179], v[32:35]
    v_mfma_f32_16x16x32_bf16 v[36:39], v[92:95], v[180:183], v[36:39]
    ds_read_b64_tr_b16 v[84:85], v17 offset:30728
    ds_read_b64_tr_b16 v[86:87], v17 offset:30808
    s_waitcnt lgkmcnt(10)
    v_mfma_f32_16x16x32_bf16 v[40:43], v[64:67], v[176:179], v[40:43]
    v_mfma_f32_16x16x32_bf16 v[44:47], v[64:67], v[180:183], v[44:47]
    ds_read_b64_tr_b16 v[88:89], v18 offset:30720
    ds_read_b64_tr_b16 v[90:91], v18 offset:30800
    s_waitcnt lgkmcnt(10)
    v_mfma_f32_16x16x32_bf16 v[24:27], v[68:71], v[184:187], v[24:27]
    v_mfma_f32_16x16x32_bf16 v[28:31], v[68:71], v[188:191], v[28:31]
    ds_read_b64_tr_b16 v[92:93], v17 offset:33280
    ds_read_b64_tr_b16 v[94:95], v17 offset:33360
    s_waitcnt lgkmcnt(10)
    v_mfma_f32_16x16x32_bf16 v[32:35], v[72:75], v[184:187], v[32:35]
    v_mfma_f32_16x16x32_bf16 v[36:39], v[72:75], v[188:191], v[36:39]
    ds_read_b64_tr_b16 v[64:65], v17 offset:33288
    ds_read_b64_tr_b16 v[66:67], v17 offset:33368
    s_waitcnt lgkmcnt(10)
    v_mfma_f32_16x16x32_bf16 v[40:43], v[76:79], v[184:187], v[40:43]
    v_mfma_f32_16x16x32_bf16 v[44:47], v[76:79], v[188:191], v[44:47]
    ds_read_b64_tr_b16 v[68:69], v18 offset:33280
    ds_read_b64_tr_b16 v[70:71], v18 offset:33360
    s_waitcnt lgkmcnt(10)
    v_mfma_f32_16x16x32_bf16 v[24:27], v[80:83], v[192:195], v[24:27]
    v_mfma_f32_16x16x32_bf16 v[28:31], v[80:83], v[196:199], v[28:31]
    ds_read_b64_tr_b16 v[72:73], v17 offset:35840
    ds_read_b64_tr_b16 v[74:75], v17 offset:35920
    s_waitcnt lgkmcnt(10)
    v_mfma_f32_16x16x32_bf16 v[32:35], v[84:87], v[192:195], v[32:35]
    v_mfma_f32_16x16x32_bf16 v[36:39], v[84:87], v[196:199], v[36:39]
    ds_read_b64_tr_b16 v[76:77], v17 offset:35848
    ds_read_b64_tr_b16 v[78:79], v17 offset:35928
    s_waitcnt lgkmcnt(10)
    v_mfma_f32_16x16x32_bf16 v[40:43], v[88:91], v[192:195], v[40:43]
    v_mfma_f32_16x16x32_bf16 v[44:47], v[88:91], v[196:199], v[44:47]
    ds_read_b64_tr_b16 v[80:81], v18 offset:35840
    ds_read_b64_tr_b16 v[82:83], v18 offset:35920
    s_waitcnt lgkmcnt(10)
    v_mfma_f32_16x16x32_bf16 v[24:27], v[92:95], v[200:203], v[24:27]
    v_mfma_f32_16x16x32_bf16 v[28:31], v[92:95], v[204:207], v[28:31]
    ds_read_b64_tr_b16 v[84:85], v17 offset:38400
    ds_read_b64_tr_b16 v[86:87], v17 offset:38480
    s_waitcnt lgkmcnt(10)
    v_mfma_f32_16x16x32_bf16 v[32:35], v[64:67], v[200:203], v[32:35]
    v_mfma_f32_16x16x32_bf16 v[36:39], v[64:67], v[204:207], v[36:39]
    ds_read_b64_tr_b16 v[88:89], v17 offset:38408
    ds_read_b64_tr_b16 v[90:91], v17 offset:38488
    s_waitcnt lgkmcnt(10)
    v_mfma_f32_16x16x32_bf16 v[40:43], v[68:71], v[200:203], v[40:43]
    v_mfma_f32_16x16x32_bf16 v[44:47], v[68:71], v[204:207], v[44:47]
    ds_read_b64_tr_b16 v[92:93], v18 offset:38400
    ds_read_b64_tr_b16 v[94:95], v18 offset:38480
    s_waitcnt lgkmcnt(10)
    v_mfma_f32_16x16x32_bf16 v[24:27], v[72:75], v[208:211], v[24:27]
    v_mfma_f32_16x16x32_bf16 v[28:31], v[72:75], v[212:215], v[28:31]
    s_waitcnt vmcnt(0)
    s_barrier
    v_add_u32 v17, -30720, v17
    v_add_u32 v18, -30720, v18
    ds_read_b64_tr_b16 v[64:65], v17 offset:0
    ds_read_b64_tr_b16 v[66:67], v17 offset:80
    s_waitcnt lgkmcnt(10)
    v_mfma_f32_16x16x32_bf16 v[32:35], v[76:79], v[208:211], v[32:35]
    v_mfma_f32_16x16x32_bf16 v[36:39], v[76:79], v[212:215], v[36:39]
    ds_read_b64_tr_b16 v[68:69], v17 offset:8
    ds_read_b64_tr_b16 v[70:71], v17 offset:88
    s_waitcnt lgkmcnt(10)
    v_mfma_f32_16x16x32_bf16 v[40:43], v[80:83], v[208:211], v[40:43]
    v_mfma_f32_16x16x32_bf16 v[44:47], v[80:83], v[212:215], v[44:47]
    ds_read_b64_tr_b16 v[72:73], v18 offset:0
    ds_read_b64_tr_b16 v[74:75], v18 offset:80
    s_waitcnt lgkmcnt(10)
    v_mfma_f32_16x16x32_bf16 v[24:27], v[84:87], v[216:219], v[24:27]
    v_mfma_f32_16x16x32_bf16 v[28:31], v[84:87], v[220:223], v[28:31]
    ds_read_b64_tr_b16 v[76:77], v17 offset:2560
    ds_read_b64_tr_b16 v[78:79], v17 offset:2640
    s_waitcnt lgkmcnt(10)
    v_mfma_f32_16x16x32_bf16 v[32:35], v[88:91], v[216:219], v[32:35]
    v_mfma_f32_16x16x32_bf16 v[36:39], v[88:91], v[220:223], v[36:39]
    ds_read_b64_tr_b16 v[80:81], v17 offset:2568
    ds_read_b64_tr_b16 v[82:83], v17 offset:2648
    s_waitcnt lgkmcnt(10)
    v_mfma_f32_16x16x32_bf16 v[40:43], v[92:95], v[216:219], v[40:43]
    v_mfma_f32_16x16x32_bf16 v[44:47], v[92:95], v[220:223], v[44:47]
    ds_read_b64_tr_b16 v[84:85], v18 offset:2560
    ds_read_b64_tr_b16 v[86:87], v18 offset:2640
    s_waitcnt lgkmcnt(10)
    v_mfma_f32_16x16x32_bf16 v[24:27], v[64:67], v[224:227], v[24:27]
    v_mfma_f32_16x16x32_bf16 v[28:31], v[64:67], v[228:231], v[28:31]
    ds_read_b64_tr_b16 v[88:89], v17 offset:5120
    ds_read_b64_tr_b16 v[90:91], v17 offset:5200
    s_waitcnt lgkmcnt(10)
    v_mfma_f32_16x16x32_bf16 v[32:35], v[68:71], v[224:227], v[32:35]
    v_mfma_f32_16x16x32_bf16 v[36:39], v[68:71], v[228:231], v[36:39]
    ds_read_b64_tr_b16 v[92:93], v17 offset:5128
    ds_read_b64_tr_b16 v[94:95], v17 offset:5208
    s_waitcnt lgkmcnt(10)
    v_mfma_f32_16x16x32_bf16 v[40:43], v[72:75], v[224:227], v[40:43]
    v_mfma_f32_16x16x32_bf16 v[44:47], v[72:75], v[228:231], v[44:47]
    ds_read_b64_tr_b16 v[64:65], v18 offset:5120
    ds_read_b64_tr_b16 v[66:67], v18 offset:5200
    s_waitcnt lgkmcnt(10)
    v_mfma_f32_16x16x32_bf16 v[24:27], v[76:79], v[232:235], v[24:27]
    v_mfma_f32_16x16x32_bf16 v[28:31], v[76:79], v[236:239], v[28:31]
    ds_read_b64_tr_b16 v[68:69], v17 offset:7680
    ds_read_b64_tr_b16 v[70:71], v17 offset:7760
    s_waitcnt lgkmcnt(10)
    v_mfma_f32_16x16x32_bf16 v[32:35], v[80:83], v[232:235], v[32:35]
    v_mfma_f32_16x16x32_bf16 v[36:39], v[80:83], v[236:239], v[36:39]
    ds_read_b64_tr_b16 v[72:73], v17 offset:7688
    ds_read_b64_tr_b16 v[74:75], v17 offset:7768
    s_waitcnt lgkmcnt(10)
    v_mfma_f32_16x16x32_bf16 v[40:43], v[84:87], v[232:235], v[40:43]
    v_mfma_f32_16x16x32_bf16 v[44:47], v[84:87], v[236:239], v[44:47]
    ds_read_b64_tr_b16 v[76:77], v18 offset:7680
    ds_read_b64_tr_b16 v[78:79], v18 offset:7760
    s_waitcnt lgkmcnt(10)
    v_mfma_f32_16x16x32_bf16 v[24:27], v[88:91], v[240:243], v[24:27]
    v_mfma_f32_16x16x32_bf16 v[28:31], v[88:91], v[244:247], v[28:31]
    s_waitcnt lgkmcnt(8)
    v_mfma_f32_16x16x32_bf16 v[32:35], v[92:95], v[240:243], v[32:35]
    v_mfma_f32_16x16x32_bf16 v[36:39], v[92:95], v[244:247], v[36:39]
    s_waitcnt lgkmcnt(6)
    v_mfma_f32_16x16x32_bf16 v[40:43], v[64:67], v[240:243], v[40:43]
    v_mfma_f32_16x16x32_bf16 v[44:47], v[64:67], v[244:247], v[44:47]
    s_waitcnt lgkmcnt(4)
    v_mfma_f32_16x16x32_bf16 v[24:27], v[68:71], v[248:251], v[24:27]
    v_mfma_f32_16x16x32_bf16 v[28:31], v[68:71], v[252:255], v[28:31]
    s_waitcnt lgkmcnt(2)
    v_mfma_f32_16x16x32_bf16 v[32:35], v[72:75], v[248:251], v[32:35]
    v_mfma_f32_16x16x32_bf16 v[36:39], v[72:75], v[252:255], v[36:39]
    s_waitcnt lgkmcnt(0)
    v_mfma_f32_16x16x32_bf16 v[40:43], v[76:79], v[248:251], v[40:43]
    v_mfma_f32_16x16x32_bf16 v[44:47], v[76:79], v[252:255], v[44:47]
    s_lshl_b32 s50, s5, 10
    s_add_u32 s50, s50, 65536
    v_lshlrev_b32 v5, 6, v2
    v_add_u32 v5, s50, v5
    v_lshlrev_b32 v4, 12, v3
    s_lshl_b32 s50, s3, 4
    v_add_u32 v21, s50, v2
    v_lshl_add_u32 v4, v21, 4, v4
    s_mov_b64 exec, 0xffff
    s_mov_b32 s30, 0
L_s1_2:
    global_load_dword v22, v5, s[16:17] sc1
    s_add_u32 s30, s30, 1
    s_cmp_gt_u32 s30, 262144
    s_cbranch_scc1 L_s1x_3
    s_waitcnt vmcnt(0)
    v_cmp_ne_u32 vcc, s24, v22
    s_nop 4
    s_cbranch_vccnz L_s1_2
L_s1x_3:
    s_waitcnt vmcnt(0)
    s_mov_b64 exec, -1
    s_lshl_b32 s50, s5, 16
    s_add_u32 s50, s50, 6815744
    s_add_u32 s51, s50, 16384
    s_add_u32 s52, s50, 32768
    s_add_u32 s53, s50, 49152
    ds_read_b64_tr_b16 v[64:65], v19 offset:0
    ds_read_b64_tr_b16 v[66:67], v19 offset:192
    ds_read_b64_tr_b16 v[68:69], v20 offset:0
    ds_read_b64_tr_b16 v[72:73], v19 offset:16
    ds_read_b64_tr_b16 v[74:75], v19 offset:208
    ds_read_b64_tr_b16 v[76:77], v20 offset:16
    ds_read_b64_tr_b16 v[80:81], v19 offset:32
    ds_read_b64_tr_b16 v[82:83], v19 offset:224
    ds_read_b64_tr_b16 v[84:85], v20 offset:32
    v_mov_b32 v70, 0
    v_mov_b32 v71, 0
    v_mov_b32 v78, 0
    v_mov_b32 v79, 0
    v_mov_b32 v86, 0
    v_mov_b32 v87, 0
    v_cvt_pk_bf16_f32 v24, v24, v25
    v_cvt_pk_bf16_f32 v25, v26, v27
    v_cvt_pk_bf16_f32 v26, v32, v33
    v_cvt_pk_bf16_f32 v27, v34, v35
    v_cvt_pk_bf16_f32 v32, v40, v41
    v_cvt_pk_bf16_f32 v33, v42, v43
    v_mov_b32 v34, 0
    v_mov_b32 v35, 0
    v_cvt_pk_bf16_f32 v28, v28, v29
    v_cvt_pk_bf16_f32 v29, v30, v31
    v_cvt_pk_bf16_f32 v30, v36, v37
    v_cvt_pk_bf16_f32 v31, v38, v39
    v_cvt_pk_bf16_f32 v36, v44, v45
    v_cvt_pk_bf16_f32 v37, v46, v47
    v_mov_b32 v38, 0
    v_mov_b32 v39, 0
    s_waitcnt lgkmcnt(0)
    v_mfma_f32_16x16x32_bf16 v[48:51], v[64:67], v[24:27], 0
    v_mfma_f32_16x16x32_bf16 v[56:59], v[72:75], v[24:27], 0
    v_mfma_f32_16x16x32_bf16 v[88:91], v[80:83], v[24:27], 0
    v_mfma_f32_16x16x32_bf16 v[48:51], v[68:71], v[32:35], v[48:51]
    v_mfma_f32_16x16x32_bf16 v[56:59], v[76:79], v[32:35], v[56:59]
    v_mfma_f32_16x16x32_bf16 v[88:91], v[84:87], v[32:35], v[88:91]
    v_mfma_f32_16x16x32_bf16 v[52:55], v[64:67], v[28:31], 0
    v_mfma_f32_16x16x32_bf16 v[60:63], v[72:75], v[28:31], 0
    v_mfma_f32_16x16x32_bf16 v[92:95], v[80:83], v[28:31], 0
    v_mfma_f32_16x16x32_bf16 v[52:55], v[68:71], v[36:39], v[52:55]
    v_mfma_f32_16x16x32_bf16 v[60:63], v[76:79], v[36:39], v[60:63]
    v_mfma_f32_16x16x32_bf16 v[92:95], v[84:87], v[36:39], v[92:95]
    v_max3_f32 v8, v48, v49, v50
    v_min3_f32 v10, v48, v49, v50
    v_max3_f32 v8, v8, v51, v56
    v_min3_f32 v10, v10, v51, v56
    v_max3_f32 v8, v8, v57, v58
    v_min3_f32 v10, v10, v57, v58
    v_max3_f32 v8, v8, v59, v88
    v_min3_f32 v10, v10, v59, v88
    v_max_f32 v8, v8, v89
    v_min_f32 v10, v10, v89
    buffer_load_dwordx4 v[96:99], v4, s[60:63], s50 offen offset:0 sc1
    v_mov_b32 v9, v8
    v_mov_b32 v11, v10
    s_nop 0
    v_permlane16_swap_b32 v8, v9
    v_permlane16_swap_b32 v10, v11
    v_max_f32 v8, v8, v9
    v_min_f32 v10, v10, v11
    v_mul_f32 v8, s22, v8
    v_mul_f32 v10, s22, v10
    v_pk_fma_f32 v[24:25], v[48:49], s[22:23], v[8:9] op_sel_hi:[1,1,0] neg_lo:[0,0,1] neg_hi:[0,0,1]
    v_pk_fma_f32 v[48:49], v[48:49], s[22:23], v[10:11] op_sel_hi:[1,1,0] neg_lo:[1,0,0] neg_hi:[1,0,0]
    buffer_load_dwordx4 v[100:103], v4, s[60:63], s51 offen offset:0 sc1
    v_pk_fma_f32 v[26:27], v[50:51], s[22:23], v[8:9] op_sel_hi:[1,1,0] neg_lo:[0,0,1] neg_hi:[0,0,1]
    v_pk_fma_f32 v[50:51], v[50:51], s[22:23], v[10:11] op_sel_hi:[1,1,0] neg_lo:[1,0,0] neg_hi:[1,0,0]
    v_pk_fma_f32 v[32:33], v[56:57], s[22:23], v[8:9] op_sel_hi:[1,1,0] neg_lo:[0,0,1] neg_hi:[0,0,1]
    v_pk_fma_f32 v[56:57], v[56:57], s[22:23], v[10:11] op_sel_hi:[1,1,0] neg_lo:[1,0,0] neg_hi:[1,0,0]
    v_pk_fma_f32 v[34:35], v[58:59], s[22:23], v[8:9] op_sel_hi:[1,1,0] neg_lo:[0,0,1] neg_hi:[0,0,1]
    v_pk_fma_f32 v[58:59], v[58:59], s[22:23], v[10:11] op_sel_hi:[1,1,0] neg_lo:[1,0,0] neg_hi:[1,0,0]
    v_pk_fma_f32 v[40:41], v[88:89], s[22:23], v[8:9] op_sel_hi:[1,1,0] neg_lo:[0,0,1] neg_hi:[0,0,1]
    v_pk_fma_f32 v[88:89], v[88:89], s[22:23], v[10:11] op_sel_hi:[1,1,0] neg_lo:[1,0,0] neg_hi:[1,0,0]
    v_exp_f32 v24, v24
    buffer_load_dwordx4 v[104:107], v4, s[60:63], s52 offen offset:0 sc1
    v_exp_f32 v48, v48
    v_exp_f32 v25, v25
    v_exp_f32 v49, v49
    v_exp_f32 v26, v26
    v_exp_f32 v50, v50
    v_exp_f32 v27, v27
    v_exp_f32 v51, v51
    v_exp_f32 v32, v32
    v_exp_f32 v56, v56
    v_exp_f32 v33, v33
    buffer_load_dwordx4 v[108:111], v4, s[60:63], s53 offen offset:0 sc1
    v_exp_f32 v57, v57
    v_exp_f32 v34, v34
    v_exp_f32 v58, v58
    v_exp_f32 v35, v35
    v_exp_f32 v59, v59
    v_exp_f32 v40, v40
    v_exp_f32 v88, v88
    v_exp_f32 v41, v41
    v_exp_f32 v89, v89
    buffer_load_dwordx4 v[112:115], v4, s[60:63], s50 offen offset:1024 sc1
    v_pk_add_f32 v[12:13], v[24:25], v[26:27]
    v_pk_add_f32 v[22:23], v[48:49], v[50:51]
    v_pk_add_f32 v[12:13], v[12:13], v[32:33]
    v_pk_add_f32 v[22:23], v[22:23], v[56:57]
    v_pk_add_f32 v[12:13], v[12:13], v[34:35]
    v_pk_add_f32 v[22:23], v[22:23], v[58:59]
    v_pk_add_f32 v[12:13], v[12:13], v[40:41]
    v_pk_add_f32 v[22:23], v[22:23], v[88:89]
    v_add_f32 v12, v12, v13
    v_add_f32 v22, v22, v23
    buffer_load_dwordx4 v[116:119], v4, s[60:63], s51 offen offset:1024 sc1
    v_mov_b32 v13, v12
    v_mov_b32 v23, v22
    s_nop 0
    v_permlane16_swap_b32 v12, v13
    v_permlane16_swap_b32 v22, v23
    v_add_f32 v12, v12, v13
    v_add_f32 v22, v22, v23
    v_rcp_f32 v12, v12
    v_rcp_f32 v22, v22
    v_pk_mul_f32 v[24:25], v[24:25], v[12:13] op_sel_hi:[1,0]
    buffer_load_dwordx4 v[120:123], v4, s[60:63], s52 offen offset:1024 sc1
    v_pk_mul_f32 v[48:49], v[48:49], v[22:23] op_sel_hi:[1,0]
    v_pk_mul_f32 v[26:27], v[26:27], v[12:13] op_sel_hi:[1,0]
    v_pk_mul_f32 v[50:51], v[50:51], v[22:23] op_sel_hi:[1,0]
    v_pk_mul_f32 v[32:33], v[32:33], v[12:13] op_sel_hi:[1,0]
    v_pk_mul_f32 v[56:57], v[56:57], v[22:23] op_sel_hi:[1,0]
    v_pk_mul_f32 v[34:35], v[34:35], v[12:13] op_sel_hi:[1,0]
    v_pk_mul_f32 v[58:59], v[58:59], v[22:23] op_sel_hi:[1,0]
    v_pk_mul_f32 v[40:41], v[40:41], v[12:13] op_sel_hi:[1,0]
    v_pk_mul_f32 v[88:89], v[88:89], v[22:23] op_sel_hi:[1,0]
    v_cvt_pk_bf16_f32 v24, v24, v25
    buffer_load_dwordx4 v[124:127], v4, s[60:63], s53 offen offset:1024 sc1
    v_cvt_pk_bf16_f32 v25, v26, v27
    v_cvt_pk_bf16_f32 v26, v32, v33
    v_cvt_pk_bf16_f32 v27, v34, v35
    v_cvt_pk_bf16_f32 v32, v40, v41
    v_cvt_pk_bf16_f32 v33, v48, v49
    v_cvt_pk_bf16_f32 v34, v50, v51
    v_cvt_pk_bf16_f32 v35, v56, v57
    v_cvt_pk_bf16_f32 v40, v58, v59
    v_cvt_pk_bf16_f32 v41, v88, v89
    v_mov_b32 v42, 0
    v_mov_b32 v43, 0
    v_max3_f32 v8, v52, v53, v54
    v_min3_f32 v10, v52, v53, v54
    v_max3_f32 v8, v8, v55, v60
    v_min3_f32 v10, v10, v55, v60
    v_max3_f32 v8, v8, v61, v62
    v_min3_f32 v10, v10, v61, v62
    v_max3_f32 v8, v8, v63, v92
    v_min3_f32 v10, v10, v63, v92
    v_max_f32 v8, v8, v93
    v_min_f32 v10, v10, v93
    buffer_load_dwordx4 v[128:131], v4, s[60:63], s50 offen offset:2048 sc1
    v_mov_b32 v9, v8
    v_mov_b32 v11, v10
    s_nop 0
    v_permlane16_swap_b32 v8, v9
    v_permlane16_swap_b32 v10, v11
    v_max_f32 v8, v8, v9
    v_min_f32 v10, v10, v11
    v_mul_f32 v8, s22, v8
    v_mul_f32 v10, s22, v10
    v_pk_fma_f32 v[28:29], v[52:53], s[22:23], v[8:9] op_sel_hi:[1,1,0] neg_lo:[0,0,1] neg_hi:[0,0,1]
    v_pk_fma_f32 v[52:53], v[52:53], s[22:23], v[10:11] op_sel_hi:[1,1,0] neg_lo:[1,0,0] neg_hi:[1,0,0]
    buffer_load_dwordx4 v[132:135], v4, s[60:63], s51 offen offset:2048 sc1
    v_pk_fma_f32 v[30:31], v[54:55], s[22:23], v[8:9] op_sel_hi:[1,1,0] neg_lo:[0,0,1] neg_hi:[0,0,1]
    v_pk_fma_f32 v[54:55], v[54:55], s[22:23], v[10:11] op_sel_hi:[1,1,0] neg_lo:[1,0,0] neg_hi:[1,0,0]
    v_pk_fma_f32 v[36:37], v[60:61], s[22:23], v[8:9] op_sel_hi:[1,1,0] neg_lo:[0,0,1] neg_hi:[0,0,1]
    v_pk_fma_f32 v[60:61], v[60:61], s[22:23], v[10:11] op_sel_hi:[1,1,0] neg_lo:[1,0,0] neg_hi:[1,0,0]
    v_pk_fma_f32 v[38:39], v[62:63], s[22:23], v[8:9] op_sel_hi:[1,1,0] neg_lo:[0,0,1] neg_hi:[0,0,1]
    v_pk_fma_f32 v[62:63], v[62:63], s[22:23], v[10:11] op_sel_hi:[1,1,0] neg_lo:[1,0,0] neg_hi:[1,0,0]
    v_pk_fma_f32 v[44:45], v[92:93], s[22:23], v[8:9] op_sel_hi:[1,1,0] neg_lo:[0,0,1] neg_hi:[0,0,1]
    v_pk_fma_f32 v[92:93], v[92:93], s[22:23], v[10:11] op_sel_hi:[1,1,0] neg_lo:[1,0,0] neg_hi:[1,0,0]
    v_exp_f32 v28, v28
    buffer_load_dwordx4 v[136:139], v4, s[60:63], s52 offen offset:2048 sc1
    v_exp_f32 v52, v52
    v_exp_f32 v29, v29
    v_exp_f32 v53, v53
    v_exp_f32 v30, v30
    v_exp_f32 v54, v54
    v_exp_f32 v31, v31
    v_exp_f32 v55, v55
    v_exp_f32 v36, v36
    v_exp_f32 v60, v60
    v_exp_f32 v37, v37
    buffer_load_dwordx4 v[140:143], v4, s[60:63], s53 offen offset:2048 sc1
    v_exp_f32 v61, v61
    v_exp_f32 v38, v38
    v_exp_f32 v62, v62
    v_exp_f32 v39, v39
    v_exp_f32 v63, v63
    v_exp_f32 v44, v44
    v_exp_f32 v92, v92
    v_exp_f32 v45, v45
    v_exp_f32 v93, v93
    buffer_load_dwordx4 v[144:147], v4, s[60:63], s50 offen offset:3072 sc1
    v_pk_add_f32 v[12:13], v[28:29], v[30:31]
    v_pk_add_f32 v[22:23], v[52:53], v[54:55]
    v_pk_add_f32 v[12:13], v[12:13], v[36:37]
    v_pk_add_f32 v[22:23], v[22:23], v[60:61]
    v_pk_add_f32 v[12:13], v[12:13], v[38:39]
    v_pk_add_f32 v[22:23], v[22:23], v[62:63]
    v_pk_add_f32 v[12:13], v[12:13], v[44:45]
    v_pk_add_f32 v[22:23], v[22:23], v[92:93]
    v_add_f32 v12, v12, v13
    v_add_f32 v22, v22, v23
    buffer_load_dwordx4 v[148:151], v4, s[60:63], s51 offen offset:3072 sc1
    v_mov_b32 v13, v12
    v_mov_b32 v23, v22
    s_nop 0
    v_permlane16_swap_b32 v12, v13
    v_permlane16_swap_b32 v22, v23
    v_add_f32 v12, v12, v13
    v_add_f32 v22, v22, v23
    v_rcp_f32 v12, v12
    v_rcp_f32 v22, v22
    v_pk_mul_f32 v[28:29], v[28:29], v[12:13] op_sel_hi:[1,0]
    buffer_load_dwordx4 v[152:155], v4, s[60:63], s52 offen offset:3072 sc1
    v_pk_mul_f32 v[52:53], v[52:53], v[22:23] op_sel_hi:[1,0]
    v_pk_mul_f32 v[30:31], v[30:31], v[12:13] op_sel_hi:[1,0]
    v_pk_mul_f32 v[54:55], v[54:55], v[22:23] op_sel_hi:[1,0]
    v_pk_mul_f32 v[36:37], v[36:37], v[12:13] op_sel_hi:[1,0]
    v_pk_mul_f32 v[60:61], v[60:61], v[22:23] op_sel_hi:[1,0]
    v_pk_mul_f32 v[38:39], v[38:39], v[12:13] op_sel_hi:[1,0]
    v_pk_mul_f32 v[62:63], v[62:63], v[22:23] op_sel_hi:[1,0]
    v_pk_mul_f32 v[44:45], v[44:45], v[12:13] op_sel_hi:[1,0]
    v_pk_mul_f32 v[92:93], v[92:93], v[22:23] op_sel_hi:[1,0]
    v_cvt_pk_bf16_f32 v28, v28, v29
    buffer_load_dwordx4 v[156:159], v4, s[60:63], s53 offen offset:3072 sc1
    v_cvt_pk_bf16_f32 v29, v30, v31
    v_cvt_pk_bf16_f32 v30, v36, v37
    v_cvt_pk_bf16_f32 v31, v38, v39
    v_cvt_pk_bf16_f32 v36, v44, v45
    v_cvt_pk_bf16_f32 v37, v52, v53
    v_cvt_pk_bf16_f32 v38, v54, v55
    v_cvt_pk_bf16_f32 v39, v60, v61
    v_cvt_pk_bf16_f32 v44, v62, v63
    v_cvt_pk_bf16_f32 v45, v92, v93
    v_mov_b32 v46, 0
    v_mov_b32 v47, 0
    s_lshl_b32 s50, s3, 4
    v_add_u32 v21, s50, v2
    v_lshlrev_b32 v21, 4, v21
    v_lshl_add_u32 v21, v3, 3, v21
    v_add_u32 v5, 76288, v21
    v_and_b32 v22, 1, v2
    v_cmp_eq_u32 vcc, 1, v22
    v_mov_b32 v22, 0x3f80
    v_mov_b32 v23, 0x3f800000
    v_cndmask_b32 v22, v22, v23, vcc
    v_lshrrev_b32 v23, 1, v2
    v_cmp_eq_u32 vcc, 0, v23
    s_nop 1
    v_cndmask_b32 v64, 0, v22, vcc
    v_cmp_eq_u32 vcc, 1, v23
    s_nop 1
    v_cndmask_b32 v65, 0, v22, vcc
    v_cmp_eq_u32 vcc, 2, v23
    s_nop 1
    v_cndmask_b32 v66, 0, v22, vcc
    v_cmp_eq_u32 vcc, 3, v23
    s_nop 1
    v_cndmask_b32 v67, 0, v22, vcc
    s_waitcnt vmcnt(12)
    s_nop 0
    v_mfma_f32_16x16x32_bf16 v[48:51], v[64:67], v[96:99], 0
    v_mfma_f32_16x16x32_bf16 v[48:51], v[64:67], v[100:103], v[48:51]
    v_mfma_f32_16x16x32_bf16 v[48:51], v[64:67], v[104:107], v[48:51]
    v_mfma_f32_16x16x32_bf16 v[48:51], v[64:67], v[108:111], v[48:51]
    s_waitcnt vmcnt(8)
    v_mfma_f32_16x16x32_bf16 v[52:55], v[64:67], v[112:115], 0
    v_mfma_f32_16x16x32_bf16 v[52:55], v[64:67], v[116:119], v[52:55]
    v_mfma_f32_16x16x32_bf16 v[52:55], v[64:67], v[120:123], v[52:55]
    v_mfma_f32_16x16x32_bf16 v[52:55], v[64:67], v[124:127], v[52:55]
    s_waitcnt vmcnt(4)
    v_mfma_f32_16x16x32_bf16 v[56:59], v[64:67], v[128:131], 0
    v_mfma_f32_16x16x32_bf16 v[56:59], v[64:67], v[132:135], v[56:59]
    v_mfma_f32_16x16x32_bf16 v[56:59], v[64:67], v[136:139], v[56:59]
    v_mfma_f32_16x16x32_bf16 v[56:59], v[64:67], v[140:143], v[56:59]
    s_waitcnt vmcnt(0)
    v_mfma_f32_16x16x32_bf16 v[60:63], v[64:67], v[144:147], 0
    v_mfma_f32_16x16x32_bf16 v[60:63], v[64:67], v[148:151], v[60:63]
    v_mfma_f32_16x16x32_bf16 v[60:63], v[64:67], v[152:155], v[60:63]
    v_mfma_f32_16x16x32_bf16 v[60:63], v[64:67], v[156:159], v[60:63]
    v_lshrrev_b32 v21, 3, v2
    v_lshrrev_b32 v22, 1, v3
    v_cmp_eq_u32 s[58:59], v21, v22
    v_mul_u32_u24 v22, 2016, v22
    v_and_b32 v21, 1, v3
    v_mul_u32_u24 v21, 48, v21
    v_add_u32 v22, v22, v21
    v_add_u32 v22, 76288, v22
    v_bfe_u32 v21, v2, 2, 1
    v_mul_u32_u24 v21, 10, v21
    v_and_b32 v23, 3, v2
    v_add_u32 v21, v21, v23
    v_mul_u32_u24 v12, 96, v21
    v_add_u32 v12, v12, v22
    v_mov_b32 v13, 1920
    v_cndmask_b32 v9, v13, v12, s[58:59]
    v_add_u32 v21, 8, v21
    v_cmp_le_u32 vcc, 2, v23
    v_mov_b32 v12, 20
    s_nop 0
    v_cndmask_b32 v21, v21, v12, vcc
    v_mul_u32_u24 v12, 96, v21
    v_add_u32 v12, v12, v22
    v_cndmask_b32 v10, v13, v12, s[58:59]
    v_cvt_pk_bf16_f32 v48, v48, v49
    v_cvt_pk_bf16_f32 v49, v50, v51
    v_cvt_pk_bf16_f32 v52, v52, v53
    v_cvt_pk_bf16_f32 v53, v54, v55
    v_cvt_pk_bf16_f32 v56, v56, v57
    v_cvt_pk_bf16_f32 v57, v58, v59
    v_cvt_pk_bf16_f32 v60, v60, v61
    v_cvt_pk_bf16_f32 v61, v62, v63
    s_mov_b32 exec_hi, 0
    ds_write_b64 v5, v[48:49] offset:0
    ds_write_b64 v5, v[52:53] offset:1024
    ds_write_b64 v5, v[56:57] offset:2048
    ds_write_b64 v5, v[60:61] offset:3072
    s_mov_b32 exec_hi, -1
    s_waitcnt lgkmcnt(0)
    s_barrier
    ds_read_b128 v[160:163], v9 offset:0
    ds_read_b128 v[164:167], v9 offset:16
    ds_read_b128 v[168:171], v9 offset:32
    ds_read_b128 v[172:175], v9 offset:384
    ds_read_b128 v[176:179], v9 offset:400
    ds_read_b128 v[180:183], v9 offset:416
    ds_read_b128 v[184:187], v10 offset:0
    ds_read_b128 v[188:191], v10 offset:16
    ds_read_b128 v[192:195], v10 offset:32
    s_mul_i32 s50, s3, 2560
    s_add_u32 s50, s50, 2560
    v_mul_u32_u24 v4, 80, v2
    v_mul_u32_u24 v21, 20, v3
    v_add_u32 v4, v4, v21
    v_add_u32 v4, s50, v4
    v_mul_u32_u24 v21, 80, v2
    v_add_u32 v21, s50, v21
    v_lshl_add_u32 v5, v3, 4, v21
    v_add_u32 v7, 1328, v5
    v_add_u32 v22, 1264, v5
    v_add_u32 v23, 64, v21
    v_cmp_eq_u32 vcc, 0, v3
    s_nop 1
    v_cndmask_b32 v6, v22, v23, vcc
    s_waitcnt lgkmcnt(0)
    v_mfma_f32_16x16x32_bf16 v[208:211], v[160:163], v[24:27], 0
    v_mfma_f32_16x16x32_bf16 v[212:215], v[172:175], v[24:27], 0
    v_mfma_f32_16x16x32_bf16 v[216:219], v[184:187], v[24:27], 0
    v_mfma_f32_16x16x32_bf16 v[208:211], v[164:167], v[32:35], v[208:211]
    v_mfma_f32_16x16x32_bf16 v[212:215], v[176:179], v[32:35], v[212:215]
    v_mfma_f32_16x16x32_bf16 v[216:219], v[188:191], v[32:35], v[216:219]
    v_mfma_f32_16x16x32_bf16 v[208:211], v[168:171], v[40:43], v[208:211]
    v_mfma_f32_16x16x32_bf16 v[212:215], v[180:183], v[40:43], v[212:215]
    v_mfma_f32_16x16x32_bf16 v[216:219], v[192:195], v[40:43], v[216:219]
    v_mfma_f32_16x16x32_bf16 v[220:223], v[160:163], v[28:31], 0
    v_mfma_f32_16x16x32_bf16 v[224:227], v[172:175], v[28:31], 0
    v_mfma_f32_16x16x32_bf16 v[228:231], v[184:187], v[28:31], 0
    v_mfma_f32_16x16x32_bf16 v[220:223], v[164:167], v[36:39], v[220:223]
    v_mfma_f32_16x16x32_bf16 v[224:227], v[176:179], v[36:39], v[224:227]
    v_mfma_f32_16x16x32_bf16 v[228:231], v[188:191], v[36:39], v[228:231]
    v_mfma_f32_16x16x32_bf16 v[220:223], v[168:171], v[44:47], v[220:223]
    v_mfma_f32_16x16x32_bf16 v[224:227], v[180:183], v[44:47], v[224:227]
    v_mfma_f32_16x16x32_bf16 v[228:231], v[192:195], v[44:47], v[228:231]
    s_mov_b32 s53, 0x358637bd
    v_add_f32 v218, s53, v218
    v_rcp_f32 v218, v218
    s_nop 0
    v_pk_mul_f32 v[208:209], v[208:209], v[218:219] op_sel_hi:[1,0]
    v_pk_mul_f32 v[210:211], v[210:211], v[218:219] op_sel_hi:[1,0]
    v_pk_mul_f32 v[212:213], v[212:213], v[218:219] op_sel_hi:[1,0]
    v_pk_mul_f32 v[214:215], v[214:215], v[218:219] op_sel_hi:[1,0]
    v_pk_mul_f32 v[216:217], v[216:217], v[218:219] op_sel_hi:[1,0]
    v_cvt_pk_bf16_f32 v208, v208, v209
    ds_write_b32 v4, v208 offset:0
    v_cvt_pk_bf16_f32 v210, v210, v211
    ds_write_b32 v4, v210 offset:4
    v_cvt_pk_bf16_f32 v212, v212, v213
    ds_write_b32 v4, v212 offset:8
    v_cvt_pk_bf16_f32 v214, v214, v215
    ds_write_b32 v4, v214 offset:12
    v_cvt_pk_bf16_f32 v216, v216, v217
    ds_write_b32 v4, v216 offset:16
    v_add_f32 v230, s53, v230
    v_rcp_f32 v230, v230
    s_nop 0
    v_pk_mul_f32 v[220:221], v[220:221], v[230:231] op_sel_hi:[1,0]
    v_pk_mul_f32 v[222:223], v[222:223], v[230:231] op_sel_hi:[1,0]
    v_pk_mul_f32 v[224:225], v[224:225], v[230:231] op_sel_hi:[1,0]
    v_pk_mul_f32 v[226:227], v[226:227], v[230:231] op_sel_hi:[1,0]
    v_pk_mul_f32 v[228:229], v[228:229], v[230:231] op_sel_hi:[1,0]
    v_cvt_pk_bf16_f32 v220, v220, v221
    ds_write_b32 v4, v220 offset:1280
    v_cvt_pk_bf16_f32 v222, v222, v223
    ds_write_b32 v4, v222 offset:1284
    v_cvt_pk_bf16_f32 v224, v224, v225
    ds_write_b32 v4, v224 offset:1288
    v_cvt_pk_bf16_f32 v226, v226, v227
    ds_write_b32 v4, v226 offset:1292
    v_cvt_pk_bf16_f32 v228, v228, v229
    ds_write_b32 v4, v228 offset:1296
    s_waitcnt lgkmcnt(0)
    ds_read_b128 v[96:99], v5
    ds_read_b128 v[100:103], v6
    ds_read_b128 v[104:107], v7
    s_waitcnt lgkmcnt(0)
    buffer_store_dwordx4 v[96:99], v15, s[60:63], s31 offen sc1
    buffer_store_dwordx4 v[100:103], v16, s[60:63], s31 offen sc1
    s_add_u32 s52, s31, 21248
    s_mov_b32 exec_hi, 0
    buffer_store_dwordx4 v[104:107], v15, s[60:63], s52 offen sc1
    s_mov_b32 exec_hi, -1
    s_waitcnt vmcnt(0)
    v_mov_b32 v21, s29
    v_mov_b32 v22, s24
    s_mov_b64 exec, 1
    global_store_dword v21, v22, s[16:17] sc1
    s_mov_b64 exec, -1
    s_setprio 0
    s_cmp_eq_u32 s2, 255
    s_cbranch_scc1 L_ep_5
    s_branch L_fin_4
L_ep_5:
    s_cmp_lg_u32 s3, 0
    s_cbranch_scc1 L_fin_4
    v_lshlrev_b32 v21, 6, v1
    s_mov_b32 s30, 0
L_epoll_6:
    s_mov_b32 s52, 163840
    buffer_load_dword v32, v21, s[60:63], s52 offen sc1
    s_mov_b32 s52, 167936
    buffer_load_dword v33, v21, s[60:63], s52 offen sc1
    s_mov_b32 s52, 172032
    buffer_load_dword v34, v21, s[60:63], s52 offen sc1
    s_mov_b32 s52, 176128
    buffer_load_dword v35, v21, s[60:63], s52 offen sc1
    s_mov_b32 s52, 180224
    buffer_load_dword v36, v21, s[60:63], s52 offen sc1
    s_mov_b32 s52, 184320
    buffer_load_dword v37, v21, s[60:63], s52 offen sc1
    s_mov_b32 s52, 188416
    buffer_load_dword v38, v21, s[60:63], s52 offen sc1
    s_mov_b32 s52, 192512
    buffer_load_dword v39, v21, s[60:63], s52 offen sc1
    s_mov_b32 s52, 196608
    buffer_load_dword v40, v21, s[60:63], s52 offen sc1
    s_mov_b32 s52, 200704
    buffer_load_dword v41, v21, s[60:63], s52 offen sc1
    s_mov_b32 s52, 204800
    buffer_load_dword v42, v21, s[60:63], s52 offen sc1
    s_mov_b32 s52, 208896
    buffer_load_dword v43, v21, s[60:63], s52 offen sc1
    s_mov_b32 s52, 212992
    buffer_load_dword v44, v21, s[60:63], s52 offen sc1
    s_mov_b32 s52, 217088
    buffer_load_dword v45, v21, s[60:63], s52 offen sc1
    s_mov_b32 s52, 221184
    buffer_load_dword v46, v21, s[60:63], s52 offen sc1
    s_mov_b32 s52, 225280
    buffer_load_dword v47, v21, s[60:63], s52 offen sc1
    s_mov_b32 s52, 98304
    buffer_load_dword v48, v21, s[60:63], s52 offen sc1
    s_mov_b32 s52, 102400
    buffer_load_dword v49, v21, s[60:63], s52 offen sc1
    s_mov_b32 s52, 106496
    buffer_load_dword v50, v21, s[60:63], s52 offen sc1
    s_mov_b32 s52, 110592
    buffer_load_dword v51, v21, s[60:63], s52 offen sc1
    s_mov_b32 s52, 114688
    buffer_load_dword v52, v21, s[60:63], s52 offen sc1
    s_mov_b32 s52, 118784
    buffer_load_dword v53, v21, s[60:63], s52 offen sc1
    s_mov_b32 s52, 122880
    buffer_load_dword v54, v21, s[60:63], s52 offen sc1
    s_mov_b32 s52, 126976
    buffer_load_dword v55, v21, s[60:63], s52 offen sc1
    s_mov_b32 s52, 131072
    buffer_load_dword v56, v21, s[60:63], s52 offen sc1
    s_mov_b32 s52, 135168
    buffer_load_dword v57, v21, s[60:63], s52 offen sc1
    s_add_u32 s30, s30, 1
    s_cmp_gt_u32 s30, 262144
    s_cbranch_scc1 L_epollx_7
    s_waitcnt vmcnt(0)
    s_mov_b64 s[52:53], 0
    v_cmp_ne_u32 vcc, s24, v32
    s_nop 1
    s_or_b64 s[52:53], s[52:53], vcc
    v_cmp_ne_u32 vcc, s24, v33
    s_nop 1
    s_or_b64 s[52:53], s[52:53], vcc
    v_cmp_ne_u32 vcc, s24, v34
    s_nop 1
    s_or_b64 s[52:53], s[52:53], vcc
    v_cmp_ne_u32 vcc, s24, v35
    s_nop 1
    s_or_b64 s[52:53], s[52:53], vcc
    v_cmp_ne_u32 vcc, s24, v36
    s_nop 1
    s_or_b64 s[52:53], s[52:53], vcc
    v_cmp_ne_u32 vcc, s24, v37
    s_nop 1
    s_or_b64 s[52:53], s[52:53], vcc
    v_cmp_ne_u32 vcc, s24, v38
    s_nop 1
    s_or_b64 s[52:53], s[52:53], vcc
    v_cmp_ne_u32 vcc, s24, v39
    s_nop 1
    s_or_b64 s[52:53], s[52:53], vcc
    v_cmp_ne_u32 vcc, s24, v40
    s_nop 1
    s_or_b64 s[52:53], s[52:53], vcc
    v_cmp_ne_u32 vcc, s24, v41
    s_nop 1
    s_or_b64 s[52:53], s[52:53], vcc
    v_cmp_ne_u32 vcc, s24, v42
    s_nop 1
    s_or_b64 s[52:53], s[52:53], vcc
    v_cmp_ne_u32 vcc, s24, v43
    s_nop 1
    s_or_b64 s[52:53], s[52:53], vcc
    v_cmp_ne_u32 vcc, s24, v44
    s_nop 1
    s_or_b64 s[52:53], s[52:53], vcc
    v_cmp_ne_u32 vcc, s24, v45
    s_nop 1
    s_or_b64 s[52:53], s[52:53], vcc
    v_cmp_ne_u32 vcc, s24, v46
    s_nop 1
    s_or_b64 s[52:53], s[52:53], vcc
    v_cmp_ne_u32 vcc, s24, v47
    s_nop 1
    s_or_b64 s[52:53], s[52:53], vcc
    v_cmp_ne_u32 vcc, s24, v48
    s_nop 1
    s_or_b64 s[52:53], s[52:53], vcc
    v_cmp_ne_u32 vcc, s24, v49
    s_nop 1
    s_or_b64 s[52:53], s[52:53], vcc
    v_cmp_ne_u32 vcc, s24, v50
    s_nop 1
    s_or_b64 s[52:53], s[52:53], vcc
    v_cmp_ne_u32 vcc, s24, v51
    s_nop 1
    s_or_b64 s[52:53], s[52:53], vcc
    v_cmp_ne_u32 vcc, s24, v52
    s_nop 1
    s_or_b64 s[52:53], s[52:53], vcc
    v_cmp_ne_u32 vcc, s24, v53
    s_nop 1
    s_or_b64 s[52:53], s[52:53], vcc
    v_cmp_ne_u32 vcc, s24, v54
    s_nop 1
    s_or_b64 s[52:53], s[52:53], vcc
    v_cmp_ne_u32 vcc, s24, v55
    s_nop 1
    s_or_b64 s[52:53], s[52:53], vcc
    v_cmp_ne_u32 vcc, s24, v56
    s_nop 1
    s_or_b64 s[52:53], s[52:53], vcc
    v_cmp_ne_u32 vcc, s24, v57
    s_nop 1
    s_or_b64 s[52:53], s[52:53], vcc
    s_cmp_lg_u64 s[52:53], 0
    s_cbranch_scc1 L_epoll_6
L_epollx_7:
    s_waitcnt vmcnt(0)
    s_mov_b32 s52, 0
    v_mov_b32 v21, s52
    v_mov_b32 v22, s24
    s_mov_b64 exec, 1
    global_store_dword v21, v22, s[16:17] sc1
    s_mov_b64 exec, -1
L_fin_4:
    s_endpgm
L_roleA:
    s_setprio 3
    s_load_dwordx2 s[20:21], s[0:1], 0
    s_load_dwordx4 s[8:11], s[0:1], 8
    s_load_dwordx4 s[12:15], s[0:1], 24
    s_load_dwordx2 s[18:19], s[0:1], 40
    s_load_dwordx2 s[96:97], s[0:1], 48
    s_load_dwordx2 s[26:27], s[0:1], 80
    s_load_dwordx2 s[28:29], s[0:1], 88
    s_load_dwordx2 s[16:17], s[0:1], 104
    v_lshrrev_b32 v4, 6, v0
    v_and_b32 v1, 63, v0
    v_readfirstlane_b32 s3, v4
    v_and_b32 v2, 15, v1
    v_lshrrev_b32 v3, 4, v1
    s_sub_u32 s4, s2, 256
    s_mul_i32 s50, s4, 3
    s_lshl_b32 s51, s4, 1
    s_add_u32 s51, s51, 144
    s_cmp_lt_u32 s4, 144
    s_cselect_b32 s50, s50, s51
    s_cselect_b32 s51, 3, 2
    s_add_u32 s5, s50, s3
    s_mul_i32 s6, s3, 21824
    s_cmp_lt_u32 s3, s51
    s_cselect_b32 s7, 1, 0
    s_waitcnt lgkmcnt(0)
    s_load_dword s25, s[16:17], 0
    s_mov_b32 s60, s16
    s_mov_b32 s61, s17
    s_mov_b32 s62, 268435456
    s_mov_b32 s63, 0x20000
    s_mov_b32 s32, s20
    s_mov_b32 s33, s21
    s_mov_b32 s34, 2621440
    s_mov_b32 s35, 0x20000
    s_mov_b32 s36, s28
    s_mov_b32 s37, s29
    s_mov_b32 s38, 5242880
    s_mov_b32 s39, 0x20000
    s_mov_b32 s42, 4096
    s_mov_b32 s41, 0
    s_mov_b32 s43, 98304
    s_cmp_eq_u32 s7, 0
    s_cbranch_scc1 L_noparam_8
    s_lshl_b32 s50, s5, 8
    v_lshlrev_b32 v4, 2, v1
    v_add_u32 v4, s50, v4
    global_load_dword v8, v4, s[8:9]
    global_load_dword v9, v4, s[10:11]
    global_load_dword v10, v4, s[12:13]
    global_load_dword v11, v4, s[14:15]
    s_lshr_b32 s50, s5, 1
    s_lshl_b32 s50, s50, 2
    s_add_u32 s52, s18, s50
    s_addc_u32 s53, s19, 0
    s_load_dword s31, s[52:53], 0
L_noparam_8:
    s_cmp_lg_u32 s7, 0
    s_cbranch_scc1 L_c0_12
    s_mov_b32 s49, s4
    s_cmp_eq_u32 s3, 3
    s_cbranch_scc1 L_w3_11
    s_cmp_lt_u32 s4, 176
    s_cbranch_scc1 L_barpost_13
    s_cmp_lg_u32 s3, 2
    s_cbranch_scc1 L_barpost_13
    s_add_u32 s49, s4, 72
L_w3_11:
    s_and_b32 s50, s49, 31
    s_lshr_b32 s51, s49, 5
    s_lshl_b32 s52, s49, 6
    s_add_u32 s42, s52, 4096
    s_mul_i32 s56, s50, 81920
    s_lshl_b32 s57, s51, 7
    s_add_u32 s56, s56, s57
    v_lshrrev_b32 v4, 3, v1
    v_mul_u32_u24 v4, 1280, v4
    v_bfe_u32 v5, v1, 4, 1
    v_lshlrev_b32 v5, 1, v5
    v_and_b32 v6, 7, v1
    v_xor_b32 v5, v5, v6
    v_lshl_add_u32 v8, v5, 4, v4
    v_xor_b32 v5, 4, v5
    v_lshl_add_u32 v9, v5, 4, v4
    s_add_u32 m0, s6, 0
    s_nop 0
    buffer_load_dwordx4 v8, s[32:35], s56 offen lds
    s_add_u32 s56, s56, 10240
    s_add_u32 m0, s6, 1024
    s_nop 0
    buffer_load_dwordx4 v9, s[32:35], s56 offen lds
    s_add_u32 s56, s56, 10240
    s_add_u32 m0, s6, 2048
    s_nop 0
    buffer_load_dwordx4 v8, s[32:35], s56 offen lds
    s_add_u32 s56, s56, 10240
    s_add_u32 m0, s6, 3072
    s_nop 0
    buffer_load_dwordx4 v9, s[32:35], s56 offen lds
    s_add_u32 s56, s56, 10240
    s_add_u32 m0, s6, 4096
    s_nop 0
    buffer_load_dwordx4 v8, s[32:35], s56 offen lds
    s_add_u32 s56, s56, 10240
    s_add_u32 m0, s6, 5120
    s_nop 0
    buffer_load_dwordx4 v9, s[32:35], s56 offen lds
    s_add_u32 s56, s56, 10240
    s_add_u32 m0, s6, 6144
    s_nop 0
    buffer_load_dwordx4 v8, s[32:35], s56 offen lds
    s_add_u32 s56, s56, 10240
    s_add_u32 m0, s6, 7168
    s_nop 0
    buffer_load_dwordx4 v9, s[32:35], s56 offen lds
    s_add_u32 s56, s56, 10240
    s_waitcnt lgkmcnt(0)
    s_mul_i32 s24, s25, 0x9E3779B1
    s_add_u32 s24, s24, 0x7F4A7C15
    v_lshrrev_b32 v4, 2, v2
    v_lshlrev_b32 v5, 3, v3
    v_add_u32 v5, 3, v5
    v_sub_u32 v5, v5, v4
    v_lshlrev_b32 v5, 7, v5
    v_add_u32 v5, s6, v5
    v_and_b32 v6, 1, v1
    v_lshl_add_u32 v5, v6, 3, v5
    v_bfe_u32 v6, v1, 1, 1
    v_lshl_add_u32 v5, v6, 4, v5
    v_and_b32 v4, 2, v4
    v_xor_b32 v4, 2, v4
    v_and_b32 v6, 1, v3
    v_lshl_or_b32 v4, v6, 2, v4
    v_xor_b32 v6, 0, v4
    v_lshl_add_u32 v10, v6, 4, v5
    v_xor_b32 v6, 2, v4
    v_lshl_add_u32 v11, v6, 4, v5
    v_xor_b32 v6, 4, v4
    v_lshl_add_u32 v12, v6, 4, v5
    v_xor_b32 v6, 6, v4
    v_lshl_add_u32 v13, v6, 4, v5
    s_lshl_b32 s56, s51, 18
    s_lshl_b32 s57, s50, 7
    s_add_u32 s56, s56, s57
    s_add_u32 s56, s56, 1048576
    s_waitcnt vmcnt(4)
    ds_read_b64_tr_b16 v[16:17], v10 offset:512
    ds_read_b64_tr_b16 v[18:19], v10 offset:0
    ds_read_b64_tr_b16 v[24:25], v11 offset:512
    ds_read_b64_tr_b16 v[26:27], v11 offset:0
    ds_read_b64_tr_b16 v[32:33], v12 offset:512
    ds_read_b64_tr_b16 v[34:35], v12 offset:0
    ds_read_b64_tr_b16 v[40:41], v13 offset:512
    ds_read_b64_tr_b16 v[42:43], v13 offset:0
    s_waitcnt vmcnt(0)
    ds_read_b64_tr_b16 v[20:21], v10 offset:4608
    ds_read_b64_tr_b16 v[22:23], v10 offset:4096
    ds_read_b64_tr_b16 v[28:29], v11 offset:4608
    ds_read_b64_tr_b16 v[30:31], v11 offset:4096
    ds_read_b64_tr_b16 v[36:37], v12 offset:4608
    ds_read_b64_tr_b16 v[38:39], v12 offset:4096
    ds_read_b64_tr_b16 v[44:45], v13 offset:4608
    ds_read_b64_tr_b16 v[46:47], v13 offset:4096
    v_lshlrev_b32 v4, 7, v2
    v_add_u32 v4, s6, v4
    v_and_b32 v6, 7, v2
    v_add_u32 v5, 0, v3
    v_xor_b32 v5, v5, v6
    v_lshl_add_u32 v8, v5, 4, v4
    v_add_u32 v5, 4, v3
    v_xor_b32 v5, v5, v6
    v_lshl_add_u32 v9, v5, 4, v4
    v_lshrrev_b32 v4, 3, v1
    v_and_b32 v5, 7, v1
    v_lshlrev_b32 v15, 12, v4
    v_lshl_add_u32 v15, v5, 4, v15
    v_xor_b32 v5, v5, v4
    v_lshlrev_b32 v5, 4, v5
    v_lshl_add_u32 v5, v4, 7, v5
    v_add_u32 v14, s6, v5
    s_waitcnt lgkmcnt(0)
    ds_write_b128 v8, v[16:19] offset:0
    ds_write_b128 v8, v[24:27] offset:2048
    ds_write_b128 v8, v[32:35] offset:4096
    ds_write_b128 v8, v[40:43] offset:6144
    ds_write_b128 v9, v[20:23] offset:0
    ds_write_b128 v9, v[28:31] offset:2048
    ds_write_b128 v9, v[36:39] offset:4096
    ds_write_b128 v9, v[44:47] offset:6144
    s_waitcnt lgkmcnt(0)
    ds_read_b128 v[16:19], v14 offset:0
    ds_read_b128 v[20:23], v14 offset:1024
    ds_read_b128 v[24:27], v14 offset:2048
    ds_read_b128 v[28:31], v14 offset:3072
    ds_read_b128 v[32:35], v14 offset:4096
    ds_read_b128 v[36:39], v14 offset:5120
    ds_read_b128 v[40:43], v14 offset:6144
    ds_read_b128 v[44:47], v14 offset:7168
    s_waitcnt lgkmcnt(7)
    buffer_store_dwordx4 v[16:19], v15, s[60:63], s56 offen sc1
    s_add_u32 s56, s56, 32768
    s_waitcnt lgkmcnt(6)
    buffer_store_dwordx4 v[20:23], v15, s[60:63], s56 offen sc1
    s_add_u32 s56, s56, 32768
    s_waitcnt lgkmcnt(5)
    buffer_store_dwordx4 v[24:27], v15, s[60:63], s56 offen sc1
    s_add_u32 s56, s56, 32768
    s_waitcnt lgkmcnt(4)
    buffer_store_dwordx4 v[28:31], v15, s[60:63], s56 offen sc1
    s_add_u32 s56, s56, 32768
    s_waitcnt lgkmcnt(3)
    buffer_store_dwordx4 v[32:35], v15, s[60:63], s56 offen sc1
    s_add_u32 s56, s56, 32768
    s_waitcnt lgkmcnt(2)
    buffer_store_dwordx4 v[36:39], v15, s[60:63], s56 offen sc1
    s_add_u32 s56, s56, 32768
    s_waitcnt lgkmcnt(1)
    buffer_store_dwordx4 v[40:43], v15, s[60:63], s56 offen sc1
    s_add_u32 s56, s56, 32768
    s_waitcnt lgkmcnt(0)
    buffer_store_dwordx4 v[44:47], v15, s[60:63], s56 offen sc1
    s_waitcnt vmcnt(0)
    v_mov_b32 v4, s42
    v_mov_b32 v5, s24
    s_mov_b64 exec, 1
    global_store_dword v4, v5, s[16:17] sc1
    s_mov_b64 exec, -1
    s_barrier
    s_branch L_postconv_10
L_barpost_13:
    s_waitcnt lgkmcnt(0)
    s_mul_i32 s24, s25, 0x9E3779B1
    s_add_u32 s24, s24, 0x7F4A7C15
    s_barrier
    s_branch L_postconv_10
L_c0_12:
    s_waitcnt lgkmcnt(0)
    s_mul_i32 s24, s25, 0x9E3779B1
    s_add_u32 s24, s24, 0x7F4A7C15
    s_setprio 0
L_conv_9:
    s_mov_b32 s44, 0x3fb8aa3b
    s_mov_b32 s45, 0x3e22f983
    s_and_b32 s50, s5, 1
    s_lshl_b32 s50, s50, 4
    s_lshr_b32 s31, s31, s50
    s_lshl_b32 s31, s31, 16
    v_mov_b32 v82, s31
    v_mul_f32 v82, s44, v82
    v_exp_f32 v82, v82
    s_nop 0
    v_cvt_pk_bf16_f32 v82, v82, v82
    v_lshlrev_b32 v82, 16, v82
    v_mov_b32 v16, 0
    v_mov_b32 v17, 0
    v_mov_b32 v18, 0
    v_mov_b32 v19, 0
    v_mov_b32 v20, 0
    v_mov_b32 v21, 0
    v_mov_b32 v22, 0
    v_mov_b32 v23, 0
    v_mov_b32 v24, 0
    v_mov_b32 v25, 0
    v_mov_b32 v26, 0
    v_mov_b32 v27, 0
    v_mov_b32 v28, 0
    v_mov_b32 v29, 0
    v_mov_b32 v30, 0
    v_mov_b32 v31, 0
    v_lshlrev_b32 v88, 2, v1
    v_add_u32 v88, s6, v88
    v_and_b32 v4, 31, v1
    v_mul_u32_u24 v4, 272, v4
    v_lshrrev_b32 v5, 5, v1
    v_lshl_add_u32 v4, v5, 4, v4
    v_add_u32 v89, s6, v4
    s_mov_b32 s46, 0
    s_waitcnt vmcnt(0)
L_kpass_14:
    v_lshrrev_b32 v4, s46, v8
    v_lshlrev_b32 v4, 16, v4
    v_lshrrev_b32 v5, s46, v9
    v_lshlrev_b32 v5, 16, v5
    v_lshrrev_b32 v48, s46, v10
    v_lshlrev_b32 v48, 16, v48
    v_lshrrev_b32 v49, s46, v11
    v_lshlrev_b32 v49, 16, v49
    v_mul_f32 v4, s44, v4
    v_exp_f32 v4, v4
    v_mul_f32 v5, v5, v82
    v_cvt_pk_bf16_f32 v4, v4, v4
    v_mul_f32 v81, s45, v5
    v_lshlrev_b32 v4, 16, v4
    v_mul_f32 v4, v4, v82
    v_mul_f32 v80, s44, v4
    v_add_f32 v6, v82, v82
    v_mul_f32 v48, v48, v6
    v_mul_f32 v49, v49, v6
    v_sub_f32 v4, 0, v80
    v_fract_f32 v5, v81
    v_exp_f32 v4, v4
    v_cos_f32 v32, v5
    v_sin_f32 v33, v5
    s_nop 0
    v_pk_mul_f32 v[32:33], v[32:33], v[4:5] op_sel_hi:[1,0]
    v_mul_f32 v4, 0xc1000000, v80
    v_mul_f32 v5, 0x41000000, v81
    v_fract_f32 v5, v5
    v_exp_f32 v4, v4
    v_cos_f32 v38, v5
    v_sin_f32 v39, v5
    s_nop 0
    v_pk_mul_f32 v[38:39], v[38:39], v[4:5] op_sel_hi:[1,0]
    v_mul_f32 v4, 0xc3800000, v80
    v_mul_f32 v5, 0x43800000, v81
    v_fract_f32 v5, v5
    v_exp_f32 v4, v4
    v_cos_f32 v44, v5
    v_sin_f32 v45, v5
    s_nop 0
    v_pk_mul_f32 v[44:45], v[44:45], v[4:5] op_sel_hi:[1,0]
    v_pk_mul_f32 v[66:67], v[32:33], v[32:33] op_sel:[0,0] op_sel_hi:[1,0]
    v_pk_fma_f32 v[34:35], v[32:33], v[32:33], v[66:67] op_sel:[1,1,0] op_sel_hi:[0,1,1] neg_lo:[1,0,0]
    v_pk_mul_f32 v[68:69], v[38:39], v[38:39] op_sel:[0,0] op_sel_hi:[1,0]
    v_pk_fma_f32 v[40:41], v[38:39], v[38:39], v[68:69] op_sel:[1,1,0] op_sel_hi:[0,1,1] neg_lo:[1,0,0]
    v_pk_mul_f32 v[70:71], v[44:45], v[44:45] op_sel:[0,0] op_sel_hi:[1,0]
    v_pk_fma_f32 v[46:47], v[44:45], v[44:45], v[70:71] op_sel:[1,1,0] op_sel_hi:[0,1,1] neg_lo:[1,0,0]
    v_pk_mul_f32 v[66:67], v[34:35], v[34:35] op_sel:[0,0] op_sel_hi:[1,0]
    v_pk_fma_f32 v[36:37], v[34:35], v[34:35], v[66:67] op_sel:[1,1,0] op_sel_hi:[0,1,1] neg_lo:[1,0,0]
    v_pk_mul_f32 v[68:69], v[40:41], v[40:41] op_sel:[0,0] op_sel_hi:[1,0]
    v_pk_fma_f32 v[42:43], v[40:41], v[40:41], v[68:69] op_sel:[1,1,0] op_sel_hi:[0,1,1] neg_lo:[1,0,0]
    v_mov_b32 v58, 1.0
    v_mov_b32 v59, 0
    v_mov_b32 v50, v48
    v_mov_b32 v51, v49
    v_mov_b32 v60, v38
    v_mov_b32 v61, v39
    v_pk_mul_f32 v[72:73], v[48:49], v[44:45] op_sel:[0,0] op_sel_hi:[1,0]
    v_pk_fma_f32 v[52:53], v[48:49], v[44:45], v[72:73] op_sel:[1,1,0] op_sel_hi:[0,1,1] neg_lo:[1,0,0]
    v_cvt_pk_bf16_f32 v84, v58, -v59
    v_cvt_pk_bf16_f32 v85, v50, v51
    v_cvt_pk_bf16_f32 v86, v60, -v61
    v_cvt_pk_bf16_f32 v87, v52, v53
    ds_write_b32 v88, v84 offset:8704
    ds_write_b32 v88, v85 offset:0
    ds_write_b32 v88, v86 offset:8976
    ds_write_b32 v88, v87 offset:1088
    ds_write_b32 v88, v87 offset:1360
    v_pk_mul_f32 v[66:67], v[48:49], v[46:47] op_sel:[0,0] op_sel_hi:[1,0]
    v_pk_mul_f32 v[68:69], v[50:51], v[32:33] op_sel:[0,0] op_sel_hi:[1,0]
    v_mov_b32 v62, v40
    v_mov_b32 v63, v41
    v_pk_mul_f32 v[72:73], v[52:53], v[34:35] op_sel:[0,0] op_sel_hi:[1,0]
    v_pk_fma_f32 v[54:55], v[48:49], v[46:47], v[66:67] op_sel:[1,1,0] op_sel_hi:[0,1,1] neg_lo:[1,0,0]
    v_pk_fma_f32 v[50:51], v[50:51], v[32:33], v[68:69] op_sel:[1,1,0] op_sel_hi:[0,1,1] neg_lo:[1,0,0]
    v_pk_fma_f32 v[52:53], v[52:53], v[34:35], v[72:73] op_sel:[1,1,0] op_sel_hi:[0,1,1] neg_lo:[1,0,0]
    v_cvt_pk_bf16_f32 v84, v54, v55
    v_cvt_pk_bf16_f32 v85, v50, v51
    v_cvt_pk_bf16_f32 v86, v62, -v63
    v_cvt_pk_bf16_f32 v87, v52, v53
    ds_write_b32 v88, v84 offset:4352
    ds_write_b32 v88, v85 offset:272
    ds_write_b32 v88, v86 offset:9248
    ds_write_b32 v88, v87 offset:1632
    v_pk_mul_f32 v[66:67], v[50:51], v[32:33] op_sel:[0,0] op_sel_hi:[1,0]
    v_pk_mul_f32 v[68:69], v[52:53], v[34:35] op_sel:[0,0] op_sel_hi:[1,0]
    v_pk_mul_f32 v[70:71], v[40:41], v[38:39] op_sel:[0,0] op_sel_hi:[1,0]
    v_pk_mul_f32 v[72:73], v[58:59], v[42:43] op_sel:[0,0] op_sel_hi:[1,0]
    v_pk_fma_f32 v[50:51], v[50:51], v[32:33], v[66:67] op_sel:[1,1,0] op_sel_hi:[0,1,1] neg_lo:[1,0,0]
    v_pk_fma_f32 v[52:53], v[52:53], v[34:35], v[68:69] op_sel:[1,1,0] op_sel_hi:[0,1,1] neg_lo:[1,0,0]
    v_pk_fma_f32 v[64:65], v[40:41], v[38:39], v[70:71] op_sel:[1,1,0] op_sel_hi:[0,1,1] neg_lo:[1,0,0]
    v_pk_fma_f32 v[58:59], v[58:59], v[42:43], v[72:73] op_sel:[1,1,0] op_sel_hi:[0,1,1] neg_lo:[1,0,0]
    v_cvt_pk_bf16_f32 v84, v50, v51
    v_cvt_pk_bf16_f32 v85, v52, v53
    v_cvt_pk_bf16_f32 v86, v64, -v65
    v_cvt_pk_bf16_f32 v87, v58, -v59
    ds_write_b32 v88, v84 offset:544
    ds_write_b32 v88, v85 offset:1904
    ds_write_b32 v88, v85 offset:3264
    ds_write_b32 v88, v85 offset:3536
    ds_write_b32 v88, v86 offset:9520
    ds_write_b32 v88, v87 offset:9792
    v_pk_mul_f32 v[66:67], v[50:51], v[32:33] op_sel:[0,0] op_sel_hi:[1,0]
    v_pk_mul_f32 v[68:69], v[52:53], v[34:35] op_sel:[0,0] op_sel_hi:[1,0]
    v_pk_mul_f32 v[70:71], v[60:61], v[42:43] op_sel:[0,0] op_sel_hi:[1,0]
    v_pk_mul_f32 v[72:73], v[62:63], v[42:43] op_sel:[0,0] op_sel_hi:[1,0]
    v_pk_fma_f32 v[50:51], v[50:51], v[32:33], v[66:67] op_sel:[1,1,0] op_sel_hi:[0,1,1] neg_lo:[1,0,0]
    v_pk_fma_f32 v[52:53], v[52:53], v[34:35], v[68:69] op_sel:[1,1,0] op_sel_hi:[0,1,1] neg_lo:[1,0,0]
    v_pk_fma_f32 v[60:61], v[60:61], v[42:43], v[70:71] op_sel:[1,1,0] op_sel_hi:[0,1,1] neg_lo:[1,0,0]
    v_pk_fma_f32 v[62:63], v[62:63], v[42:43], v[72:73] op_sel:[1,1,0] op_sel_hi:[0,1,1] neg_lo:[1,0,0]
    v_cvt_pk_bf16_f32 v84, v50, v51
    v_cvt_pk_bf16_f32 v85, v52, v53
    v_cvt_pk_bf16_f32 v86, v60, -v61
    v_cvt_pk_bf16_f32 v87, v62, -v63
    ds_write_b32 v88, v84 offset:816
    ds_write_b32 v88, v85 offset:3808
    ds_write_b32 v88, v86 offset:10064
    ds_write_b32 v88, v87 offset:10336
    v_pk_mul_f32 v[66:67], v[50:51], v[32:33] op_sel:[0,0] op_sel_hi:[1,0]
    v_pk_mul_f32 v[68:69], v[52:53], v[34:35] op_sel:[0,0] op_sel_hi:[1,0]
    v_pk_mul_f32 v[70:71], v[64:65], v[42:43] op_sel:[0,0] op_sel_hi:[1,0]
    v_pk_mul_f32 v[72:73], v[58:59], v[42:43] op_sel:[0,0] op_sel_hi:[1,0]
    v_pk_fma_f32 v[50:51], v[50:51], v[32:33], v[66:67] op_sel:[1,1,0] op_sel_hi:[0,1,1] neg_lo:[1,0,0]
    v_pk_fma_f32 v[52:53], v[52:53], v[34:35], v[68:69] op_sel:[1,1,0] op_sel_hi:[0,1,1] neg_lo:[1,0,0]
    v_pk_fma_f32 v[64:65], v[64:65], v[42:43], v[70:71] op_sel:[1,1,0] op_sel_hi:[0,1,1] neg_lo:[1,0,0]
    v_pk_fma_f32 v[58:59], v[58:59], v[42:43], v[72:73] op_sel:[1,1,0] op_sel_hi:[0,1,1] neg_lo:[1,0,0]
    v_cvt_pk_bf16_f32 v84, v50, v51
    v_cvt_pk_bf16_f32 v85, v52, v53
    v_cvt_pk_bf16_f32 v86, v64, -v65
    v_cvt_pk_bf16_f32 v87, v58, -v59
    ds_write_b32 v88, v84 offset:2176
    ds_write_b32 v88, v85 offset:4080
    ds_write_b32 v88, v86 offset:10608
    ds_write_b32 v88, v87 offset:10880
    v_pk_mul_f32 v[66:67], v[50:51], v[32:33] op_sel:[0,0] op_sel_hi:[1,0]
    v_pk_mul_f32 v[68:69], v[54:55], v[36:37] op_sel:[0,0] op_sel_hi:[1,0]
    v_pk_mul_f32 v[70:71], v[60:61], v[42:43] op_sel:[0,0] op_sel_hi:[1,0]
    v_pk_mul_f32 v[72:73], v[62:63], v[42:43] op_sel:[0,0] op_sel_hi:[1,0]
    v_pk_fma_f32 v[50:51], v[50:51], v[32:33], v[66:67] op_sel:[1,1,0] op_sel_hi:[0,1,1] neg_lo:[1,0,0]
    v_pk_fma_f32 v[52:53], v[54:55], v[36:37], v[68:69] op_sel:[1,1,0] op_sel_hi:[0,1,1] neg_lo:[1,0,0]
    v_pk_fma_f32 v[60:61], v[60:61], v[42:43], v[70:71] op_sel:[1,1,0] op_sel_hi:[0,1,1] neg_lo:[1,0,0]
    v_pk_fma_f32 v[62:63], v[62:63], v[42:43], v[72:73] op_sel:[1,1,0] op_sel_hi:[0,1,1] neg_lo:[1,0,0]
    v_cvt_pk_bf16_f32 v84, v50, v51
    v_cvt_pk_bf16_f32 v85, v52, v53
    v_cvt_pk_bf16_f32 v86, v60, -v61
    v_cvt_pk_bf16_f32 v87, v62, -v63
    ds_write_b32 v88, v84 offset:2448
    ds_write_b32 v88, v85 offset:4624
    ds_write_b32 v88, v86 offset:11152
    ds_write_b32 v88, v87 offset:11424
    v_pk_mul_f32 v[66:67], v[50:51], v[32:33] op_sel:[0,0] op_sel_hi:[1,0]
    v_pk_mul_f32 v[68:69], v[52:53], v[36:37] op_sel:[0,0] op_sel_hi:[1,0]
    v_pk_mul_f32 v[70:71], v[54:55], v[44:45] op_sel:[0,0] op_sel_hi:[1,0]
    v_pk_mul_f32 v[72:73], v[64:65], v[42:43] op_sel:[0,0] op_sel_hi:[1,0]
    v_pk_fma_f32 v[50:51], v[50:51], v[32:33], v[66:67] op_sel:[1,1,0] op_sel_hi:[0,1,1] neg_lo:[1,0,0]
    v_pk_fma_f32 v[56:57], v[52:53], v[36:37], v[68:69] op_sel:[1,1,0] op_sel_hi:[0,1,1] neg_lo:[1,0,0]
    v_pk_fma_f32 v[54:55], v[54:55], v[44:45], v[70:71] op_sel:[1,1,0] op_sel_hi:[0,1,1] neg_lo:[1,0,0]
    v_pk_fma_f32 v[64:65], v[64:65], v[42:43], v[72:73] op_sel:[1,1,0] op_sel_hi:[0,1,1] neg_lo:[1,0,0]
    v_cvt_pk_bf16_f32 v84, v50, v51
    v_cvt_pk_bf16_f32 v85, v56, v57
    v_cvt_pk_bf16_f32 v86, v54, v55
    v_cvt_pk_bf16_f32 v87, v64, -v65
    ds_write_b32 v88, v84 offset:2720
    ds_write_b32 v88, v85 offset:4896
    ds_write_b32 v88, v86 offset:5440
    ds_write_b32 v88, v87 offset:11696
    v_pk_mul_f32 v[66:67], v[50:51], v[32:33] op_sel:[0,0] op_sel_hi:[1,0]
    v_pk_mul_f32 v[68:69], v[52:53], v[44:45] op_sel:[0,0] op_sel_hi:[1,0]
    v_pk_mul_f32 v[70:71], v[56:57], v[44:45] op_sel:[0,0] op_sel_hi:[1,0]
    v_pk_mul_f32 v[72:73], v[54:55], v[44:45] op_sel:[0,0] op_sel_hi:[1,0]
    v_pk_fma_f32 v[50:51], v[50:51], v[32:33], v[66:67] op_sel:[1,1,0] op_sel_hi:[0,1,1] neg_lo:[1,0,0]
    v_pk_fma_f32 v[52:53], v[52:53], v[44:45], v[68:69] op_sel:[1,1,0] op_sel_hi:[0,1,1] neg_lo:[1,0,0]
    v_pk_fma_f32 v[56:57], v[56:57], v[44:45], v[70:71] op_sel:[1,1,0] op_sel_hi:[0,1,1] neg_lo:[1,0,0]
    v_pk_fma_f32 v[54:55], v[54:55], v[44:45], v[72:73] op_sel:[1,1,0] op_sel_hi:[0,1,1] neg_lo:[1,0,0]
    v_cvt_pk_bf16_f32 v84, v50, v51
    v_cvt_pk_bf16_f32 v85, v52, v53
    v_cvt_pk_bf16_f32 v86, v56, v57
    v_cvt_pk_bf16_f32 v87, v54, v55
    ds_write_b32 v88, v84 offset:2992
    ds_write_b32 v88, v85 offset:5712
    ds_write_b32 v88, v86 offset:5984
    ds_write_b32 v88, v87 offset:5168
    v_pk_mul_f32 v[66:67], v[54:55], v[38:39] op_sel:[0,0] op_sel_hi:[1,0]
    v_pk_mul_f32 v[68:69], v[58:59], v[42:43] op_sel:[0,0] op_sel_hi:[1,0]
    v_pk_mul_f32 v[70:71], v[60:61], v[42:43] op_sel:[0,0] op_sel_hi:[1,0]
    v_pk_mul_f32 v[72:73], v[62:63], v[42:43] op_sel:[0,0] op_sel_hi:[1,0]
    v_pk_fma_f32 v[52:53], v[54:55], v[38:39], v[66:67] op_sel:[1,1,0] op_sel_hi:[0,1,1] neg_lo:[1,0,0]
    v_pk_fma_f32 v[58:59], v[58:59], v[42:43], v[68:69] op_sel:[1,1,0] op_sel_hi:[0,1,1] neg_lo:[1,0,0]
    v_pk_fma_f32 v[60:61], v[60:61], v[42:43], v[70:71] op_sel:[1,1,0] op_sel_hi:[0,1,1] neg_lo:[1,0,0]
    v_pk_fma_f32 v[62:63], v[62:63], v[42:43], v[72:73] op_sel:[1,1,0] op_sel_hi:[0,1,1] neg_lo:[1,0,0]
    v_cvt_pk_bf16_f32 v84, v52, v53
    v_cvt_pk_bf16_f32 v85, v58, -v59
    v_cvt_pk_bf16_f32 v86, v60, -v61
    v_cvt_pk_bf16_f32 v87, v62, -v63
    ds_write_b32 v88, v84 offset:6528
    ds_write_b32 v88, v85 offset:11968
    ds_write_b32 v88, v86 offset:12240
    ds_write_b32 v88, v87 offset:12512
    v_pk_mul_f32 v[66:67], v[54:55], v[44:45] op_sel:[0,0] op_sel_hi:[1,0]
    v_pk_mul_f32 v[68:69], v[52:53], v[44:45] op_sel:[0,0] op_sel_hi:[1,0]
    v_pk_mul_f32 v[70:71], v[64:65], v[42:43] op_sel:[0,0] op_sel_hi:[1,0]
    v_pk_mul_f32 v[72:73], v[58:59], v[42:43] op_sel:[0,0] op_sel_hi:[1,0]
    v_pk_fma_f32 v[54:55], v[54:55], v[44:45], v[66:67] op_sel:[1,1,0] op_sel_hi:[0,1,1] neg_lo:[1,0,0]
    v_pk_fma_f32 v[52:53], v[52:53], v[44:45], v[68:69] op_sel:[1,1,0] op_sel_hi:[0,1,1] neg_lo:[1,0,0]
    v_pk_fma_f32 v[64:65], v[64:65], v[42:43], v[70:71] op_sel:[1,1,0] op_sel_hi:[0,1,1] neg_lo:[1,0,0]
    v_pk_fma_f32 v[58:59], v[58:59], v[42:43], v[72:73] op_sel:[1,1,0] op_sel_hi:[0,1,1] neg_lo:[1,0,0]
    v_cvt_pk_bf16_f32 v84, v54, v55
    v_cvt_pk_bf16_f32 v85, v52, v53
    v_cvt_pk_bf16_f32 v86, v64, -v65
    v_cvt_pk_bf16_f32 v87, v58, -v59
    ds_write_b32 v88, v84 offset:6800
    ds_write_b32 v88, v85 offset:7072
    ds_write_b32 v88, v86 offset:12784
    ds_write_b32 v88, v87 offset:13056
    v_pk_mul_f32 v[66:67], v[54:55], v[44:45] op_sel:[0,0] op_sel_hi:[1,0]
    v_pk_mul_f32 v[68:69], v[52:53], v[44:45] op_sel:[0,0] op_sel_hi:[1,0]
    v_pk_mul_f32 v[70:71], v[60:61], v[42:43] op_sel:[0,0] op_sel_hi:[1,0]
    v_pk_mul_f32 v[72:73], v[62:63], v[42:43] op_sel:[0,0] op_sel_hi:[1,0]
    v_pk_fma_f32 v[54:55], v[54:55], v[44:45], v[66:67] op_sel:[1,1,0] op_sel_hi:[0,1,1] neg_lo:[1,0,0]
    v_pk_fma_f32 v[52:53], v[52:53], v[44:45], v[68:69] op_sel:[1,1,0] op_sel_hi:[0,1,1] neg_lo:[1,0,0]
    v_pk_fma_f32 v[60:61], v[60:61], v[42:43], v[70:71] op_sel:[1,1,0] op_sel_hi:[0,1,1] neg_lo:[1,0,0]
    v_pk_fma_f32 v[62:63], v[62:63], v[42:43], v[72:73] op_sel:[1,1,0] op_sel_hi:[0,1,1] neg_lo:[1,0,0]
    v_cvt_pk_bf16_f32 v84, v54, v55
    v_cvt_pk_bf16_f32 v85, v52, v53
    v_cvt_pk_bf16_f32 v86, v60, -v61
    v_cvt_pk_bf16_f32 v87, v62, -v63
    ds_write_b32 v88, v84 offset:6256
    ds_write_b32 v88, v85 offset:7616
    ds_write_b32 v88, v86 offset:13328
    ds_write_b32 v88, v87 offset:13600
    v_pk_mul_f32 v[66:67], v[54:55], v[44:45] op_sel:[0,0] op_sel_hi:[1,0]
    v_pk_mul_f32 v[68:69], v[52:53], v[44:45] op_sel:[0,0] op_sel_hi:[1,0]
    v_pk_mul_f32 v[70:71], v[64:65], v[42:43] op_sel:[0,0] op_sel_hi:[1,0]
    v_pk_mul_f32 v[72:73], v[58:59], v[42:43] op_sel:[0,0] op_sel_hi:[1,0]
    v_pk_fma_f32 v[54:55], v[54:55], v[44:45], v[66:67] op_sel:[1,1,0] op_sel_hi:[0,1,1] neg_lo:[1,0,0]
    v_pk_fma_f32 v[52:53], v[52:53], v[44:45], v[68:69] op_sel:[1,1,0] op_sel_hi:[0,1,1] neg_lo:[1,0,0]
    v_pk_fma_f32 v[64:65], v[64:65], v[42:43], v[70:71] op_sel:[1,1,0] op_sel_hi:[0,1,1] neg_lo:[1,0,0]
    v_pk_fma_f32 v[58:59], v[58:59], v[42:43], v[72:73] op_sel:[1,1,0] op_sel_hi:[0,1,1] neg_lo:[1,0,0]
    v_cvt_pk_bf16_f32 v84, v54, v55
    v_cvt_pk_bf16_f32 v85, v52, v53
    v_cvt_pk_bf16_f32 v86, v64, -v65
    v_cvt_pk_bf16_f32 v87, v58, -v59
    ds_write_b32 v88, v84 offset:7888
    ds_write_b32 v88, v85 offset:8160
    ds_write_b32 v88, v86 offset:13872
    ds_write_b32 v88, v87 offset:14144
    v_pk_mul_f32 v[66:67], v[60:61], v[42:43] op_sel:[0,0] op_sel_hi:[1,0]
    v_pk_mul_f32 v[68:69], v[62:63], v[42:43] op_sel:[0,0] op_sel_hi:[1,0]
    v_pk_mul_f32 v[70:71], v[64:65], v[42:43] op_sel:[0,0] op_sel_hi:[1,0]
    v_pk_mul_f32 v[72:73], v[58:59], v[42:43] op_sel:[0,0] op_sel_hi:[1,0]
    v_pk_fma_f32 v[60:61], v[60:61], v[42:43], v[66:67] op_sel:[1,1,0] op_sel_hi:[0,1,1] neg_lo:[1,0,0]
    v_pk_fma_f32 v[62:63], v[62:63], v[42:43], v[68:69] op_sel:[1,1,0] op_sel_hi:[0,1,1] neg_lo:[1,0,0]
    v_pk_fma_f32 v[64:65], v[64:65], v[42:43], v[70:71] op_sel:[1,1,0] op_sel_hi:[0,1,1] neg_lo:[1,0,0]
    v_pk_fma_f32 v[58:59], v[58:59], v[42:43], v[72:73] op_sel:[1,1,0] op_sel_hi:[0,1,1] neg_lo:[1,0,0]
    v_cvt_pk_bf16_f32 v84, v60, -v61
    v_cvt_pk_bf16_f32 v85, v62, -v63
    v_cvt_pk_bf16_f32 v86, v64, -v65
    v_cvt_pk_bf16_f32 v87, v58, -v59
    ds_write_b32 v88, v84 offset:14416
    ds_write_b32 v88, v85 offset:14688
    ds_write_b32 v88, v86 offset:14960
    ds_write_b32 v88, v87 offset:15232
    v_pk_mul_f32 v[66:67], v[60:61], v[42:43] op_sel:[0,0] op_sel_hi:[1,0]
    v_pk_mul_f32 v[68:69], v[62:63], v[42:43] op_sel:[0,0] op_sel_hi:[1,0]
    v_pk_mul_f32 v[70:71], v[64:65], v[42:43] op_sel:[0,0] op_sel_hi:[1,0]
    v_pk_mul_f32 v[72:73], v[58:59], v[42:43] op_sel:[0,0] op_sel_hi:[1,0]
    v_pk_fma_f32 v[60:61], v[60:61], v[42:43], v[66:67] op_sel:[1,1,0] op_sel_hi:[0,1,1] neg_lo:[1,0,0]
    v_pk_fma_f32 v[62:63], v[62:63], v[42:43], v[68:69] op_sel:[1,1,0] op_sel_hi:[0,1,1] neg_lo:[1,0,0]
    v_pk_fma_f32 v[64:65], v[64:65], v[42:43], v[70:71] op_sel:[1,1,0] op_sel_hi:[0,1,1] neg_lo:[1,0,0]
    v_pk_fma_f32 v[58:59], v[58:59], v[42:43], v[72:73] op_sel:[1,1,0] op_sel_hi:[0,1,1] neg_lo:[1,0,0]
    v_cvt_pk_bf16_f32 v84, v60, -v61
    v_cvt_pk_bf16_f32 v85, v62, -v63
    v_cvt_pk_bf16_f32 v86, v64, -v65
    v_cvt_pk_bf16_f32 v87, v58, -v59
    ds_write_b32 v88, v84 offset:15504
    ds_write_b32 v88, v85 offset:15776
    ds_write_b32 v88, v86 offset:16048
    ds_write_b32 v88, v87 offset:16320
    v_pk_mul_f32 v[66:67], v[60:61], v[42:43] op_sel:[0,0] op_sel_hi:[1,0]
    v_pk_mul_f32 v[68:69], v[62:63], v[42:43] op_sel:[0,0] op_sel_hi:[1,0]
    v_pk_mul_f32 v[70:71], v[64:65], v[42:43] op_sel:[0,0] op_sel_hi:[1,0]
    v_pk_fma_f32 v[60:61], v[60:61], v[42:43], v[66:67] op_sel:[1,1,0] op_sel_hi:[0,1,1] neg_lo:[1,0,0]
    v_pk_fma_f32 v[62:63], v[62:63], v[42:43], v[68:69] op_sel:[1,1,0] op_sel_hi:[0,1,1] neg_lo:[1,0,0]
    v_pk_fma_f32 v[64:65], v[64:65], v[42:43], v[70:71] op_sel:[1,1,0] op_sel_hi:[0,1,1] neg_lo:[1,0,0]
    v_cvt_pk_bf16_f32 v84, v60, -v61
    v_cvt_pk_bf16_f32 v85, v62, -v63
    v_cvt_pk_bf16_f32 v86, v64, -v65
    ds_write_b32 v88, v84 offset:16592
    ds_write_b32 v88, v85 offset:16864
    ds_write_b32 v88, v86 offset:17136
    s_waitcnt lgkmcnt(0)
    ds_read_b128 v[92:95], v89 offset:0
    ds_read_b128 v[96:99], v89 offset:8704
    ds_read_b128 v[100:103], v89 offset:32
    ds_read_b128 v[104:107], v89 offset:8736
    s_waitcnt lgkmcnt(2)
    v_mfma_f32_32x32x16_bf16 v[16:31], v[92:95], v[96:99], v[16:31]
    ds_read_b128 v[92:95], v89 offset:64
    ds_read_b128 v[96:99], v89 offset:8768
    s_waitcnt lgkmcnt(2)
    v_mfma_f32_32x32x16_bf16 v[16:31], v[100:103], v[104:107], v[16:31]
    ds_read_b128 v[100:103], v89 offset:96
    ds_read_b128 v[104:107], v89 offset:8800
    s_waitcnt lgkmcnt(2)
    v_mfma_f32_32x32x16_bf16 v[16:31], v[92:95], v[96:99], v[16:31]
    ds_read_b128 v[92:95], v89 offset:128
    ds_read_b128 v[96:99], v89 offset:8832
    s_waitcnt lgkmcnt(2)
    v_mfma_f32_32x32x16_bf16 v[16:31], v[100:103], v[104:107], v[16:31]
    ds_read_b128 v[100:103], v89 offset:160
    ds_read_b128 v[104:107], v89 offset:8864
    s_waitcnt lgkmcnt(2)
    v_mfma_f32_32x32x16_bf16 v[16:31], v[92:95], v[96:99], v[16:31]
    ds_read_b128 v[92:95], v89 offset:192
    ds_read_b128 v[96:99], v89 offset:8896
    s_waitcnt lgkmcnt(2)
    v_mfma_f32_32x32x16_bf16 v[16:31], v[100:103], v[104:107], v[16:31]
    ds_read_b128 v[100:103], v89 offset:224
    ds_read_b128 v[104:107], v89 offset:8928
    s_waitcnt lgkmcnt(2)
    v_mfma_f32_32x32x16_bf16 v[16:31], v[92:95], v[96:99], v[16:31]
    s_waitcnt lgkmcnt(0)
    v_mfma_f32_32x32x16_bf16 v[16:31], v[100:103], v[104:107], v[16:31]
    s_cmp_lg_u32 s46, 0
    s_cbranch_scc1 L_kdone_15
    s_mov_b32 s46, 16
    s_branch L_kpass_14
L_kdone_15:
    s_nop 7
    s_nop 7
    v_cvt_pk_bf16_f32 v32, v16, v17
    v_cvt_pk_bf16_f32 v33, v18, v19
    v_cvt_pk_bf16_f32 v34, v20, v21
    v_cvt_pk_bf16_f32 v35, v22, v23
    v_cvt_pk_bf16_f32 v40, v24, v24
    v_cvt_pk_bf16_f32 v41, v24, v25
    v_cvt_pk_bf16_f32 v42, v25, v25
    v_cvt_pk_bf16_f32 v43, v26, v26
    v_and_b32 v4, 1, v1
    v_cmp_eq_u32 vcc, 1, v4
    s_nop 1
    v_cndmask_b32 v5, v27, v28, vcc
    v_cvt_pk_bf16_f32 v48, v27, v27
    v_cvt_pk_bf16_f32 v49, v27, v27
    v_cvt_pk_bf16_f32 v50, v5, v28
    v_cvt_pk_bf16_f32 v51, v28, v28
    v_cndmask_b32 v5, v29, v30, vcc
    v_cvt_pk_bf16_f32 v56, v29, v29
    v_cvt_pk_bf16_f32 v57, v29, v29
    v_cvt_pk_bf16_f32 v58, v5, v30
    v_cvt_pk_bf16_f32 v59, v30, v30
    v_and_b32 v4, 31, v1
    v_lshrrev_b32 v5, 5, v1
    v_lshl_add_u32 v6, v5, 5, v4
    v_lshlrev_b32 v6, 4, v6
    v_add_u32 v6, 64, v6
    v_add_u32 v90, s6, v6
    v_lshl_add_u32 v6, v5, 6, v4
    v_lshlrev_b32 v6, 4, v6
    v_add_u32 v6, 64, v6
    v_add_u32 v91, s6, v6
    v_mov_b32 v64, 0
    v_mov_b32 v65, 0
    v_mov_b32 v66, 0
    v_mov_b32 v67, 0
    v_lshrrev_b32 v4, 2, v1
    v_mul_u32_u24 v4, 4176, v4
    v_and_b32 v5, 3, v1
    v_lshl_add_u32 v4, v5, 4, v4
    v_add_u32 v4, s6, v4
    s_mov_b64 exec, 0xffff
    ds_write_b128 v4, v[64:67]
    s_mov_b64 exec, -1
    v_lshlrev_b32 v4, 4, v1
    v_add_u32 v4, s6, v4
    ds_write_b128 v4, v[64:67] offset:16704
    ds_write_b128 v90, v[32:35] offset:12528
    ds_write_b128 v90, v[40:43] offset:13552
    ds_write_b128 v91, v[48:51] offset:14576
    ds_write_b128 v91, v[56:59] offset:15088
    s_waitcnt lgkmcnt(0)
    ds_read_b64 v[36:37], v90 offset:12544
    ds_read_b64 v[44:45], v90 offset:13568
    ds_read_b64 v[52:53], v91 offset:14592
    ds_read_b64 v[60:61], v91 offset:15104
    s_barrier
    s_setprio 3
    s_lshr_b32 s50, s5, 6
    s_lshl_b32 s50, s50, 11
    s_add_u32 s50, s50, 4096
    v_lshlrev_b32 v4, 6, v1
    v_add_u32 v4, s50, v4
    s_mov_b32 exec_hi, 0
    s_mov_b32 s30, 0
L_s0_16:
    global_load_dword v5, v4, s[16:17] sc1
    s_add_u32 s30, s30, 1
    s_cmp_gt_u32 s30, 262144
    s_cbranch_scc1 L_s0x_17
    s_waitcnt vmcnt(0)
    v_cmp_ne_u32 vcc, s24, v5
    s_nop 4
    s_cbranch_vccnz L_s0_16
L_s0x_17:
    s_waitcnt vmcnt(0)
    s_mov_b32 exec_hi, -1
    v_lshrrev_b32 v4, 2, v1
    v_lshlrev_b32 v4, 6, v4
    v_bfe_u32 v5, v1, 4, 1
    v_lshlrev_b32 v5, 1, v5
    v_and_b32 v6, 3, v1
    v_xor_b32 v5, v5, v6
    v_lshl_add_u32 v4, v5, 4, v4
    s_lshl_b32 s50, s5, 12
    s_add_u32 s50, s50, 1048576
    s_add_u32 m0, s6, 17728
    s_nop 0
    buffer_load_dwordx4 v4, s[60:63], s50 offen offset:0 sc1 lds
    buffer_load_dwordx4 v4, s[60:63], s50 offen offset:1024 sc1 lds
    buffer_load_dwordx4 v4, s[60:63], s50 offen offset:2048 sc1 lds
    buffer_load_dwordx4 v4, s[60:63], s50 offen offset:3072 sc1 lds
    s_setprio 0
    s_waitcnt lgkmcnt(0)
    v_alignbit_b32 v64, v33, v32, 16
    v_alignbit_b32 v65, v34, v33, 16
    v_alignbit_b32 v66, v35, v34, 16
    v_alignbit_b32 v67, v36, v35, 16
    ds_write_b128 v90, v[64:67] offset:0
    v_mov_b32 v68, v33
    v_mov_b32 v69, v34
    v_mov_b32 v70, v35
    v_mov_b32 v71, v36
    ds_write_b128 v90, v[68:71] offset:4176
    v_alignbit_b32 v72, v34, v33, 16
    v_alignbit_b32 v73, v35, v34, 16
    v_alignbit_b32 v74, v36, v35, 16
    v_alignbit_b32 v75, v37, v36, 16
    ds_write_b128 v90, v[72:75] offset:8352
    v_alignbit_b32 v64, v41, v40, 16
    v_alignbit_b32 v65, v42, v41, 16
    v_alignbit_b32 v66, v43, v42, 16
    v_alignbit_b32 v67, v44, v43, 16
    ds_write_b128 v90, v[64:67] offset:1024
    v_mov_b32 v68, v41
    v_mov_b32 v69, v42
    v_mov_b32 v70, v43
    v_mov_b32 v71, v44
    ds_write_b128 v90, v[68:71] offset:5200
    v_alignbit_b32 v72, v42, v41, 16
    v_alignbit_b32 v73, v43, v42, 16
    v_alignbit_b32 v74, v44, v43, 16
    v_alignbit_b32 v75, v45, v44, 16
    ds_write_b128 v90, v[72:75] offset:9376
    v_alignbit_b32 v64, v49, v48, 16
    v_alignbit_b32 v65, v50, v49, 16
    v_alignbit_b32 v66, v51, v50, 16
    v_alignbit_b32 v67, v52, v51, 16
    ds_write_b128 v91, v[64:67] offset:2048
    v_mov_b32 v68, v49
    v_mov_b32 v69, v50
    v_mov_b32 v70, v51
    v_mov_b32 v71, v52
    ds_write_b128 v91, v[68:71] offset:6224
    v_alignbit_b32 v72, v50, v49, 16
    v_alignbit_b32 v73, v51, v50, 16
    v_alignbit_b32 v74, v52, v51, 16
    v_alignbit_b32 v75, v53, v52, 16
    ds_write_b128 v91, v[72:75] offset:10400
    v_alignbit_b32 v64, v57, v56, 16
    v_alignbit_b32 v65, v58, v57, 16
    v_alignbit_b32 v66, v59, v58, 16
    v_alignbit_b32 v67, v60, v59, 16
    ds_write_b128 v91, v[64:67] offset:2560
    v_mov_b32 v68, v57
    v_mov_b32 v69, v58
    v_mov_b32 v70, v59
    v_mov_b32 v71, v60
    ds_write_b128 v91, v[68:71] offset:6736
    v_alignbit_b32 v72, v58, v57, 16
    v_alignbit_b32 v73, v59, v58, 16
    v_alignbit_b32 v74, v60, v59, 16
    v_alignbit_b32 v75, v61, v60, 16
    ds_write_b128 v91, v[72:75] offset:10912
    s_waitcnt lgkmcnt(0)
    v_mov_b32 v64, 0
    v_mov_b32 v68, 0
    v_mov_b32 v72, 0
    v_mov_b32 v65, 0
    v_mov_b32 v69, 0
    v_mov_b32 v73, 0
    v_mov_b32 v66, 0
    v_mov_b32 v70, 0
    v_mov_b32 v74, 0
    v_mov_b32 v67, 0
    v_mov_b32 v71, 0
    v_mov_b32 v75, 0
    v_lshlrev_b32 v67, 16, v32
    v_mov_b32 v71, v32
    v_lshlrev_b32 v74, 16, v32
    v_alignbit_b32 v75, v33, v32, 16
    v_mov_b32 v4, s6
    s_mov_b64 exec, 1
    ds_write_b128 v4, v[64:67] offset:48
    ds_write_b128 v4, v[68:71] offset:4224
    ds_write_b128 v4, v[72:75] offset:8400
    s_mov_b64 exec, -1
    v_mov_b32 v16, 0
    v_mov_b32 v17, 0
    v_mov_b32 v18, 0
    v_mov_b32 v19, 0
    v_mov_b32 v20, 0
    v_mov_b32 v21, 0
    v_mov_b32 v22, 0
    v_mov_b32 v23, 0
    v_mov_b32 v24, 0
    v_mov_b32 v25, 0
    v_mov_b32 v26, 0
    v_mov_b32 v27, 0
    v_mov_b32 v28, 0
    v_mov_b32 v29, 0
    v_mov_b32 v30, 0
    v_mov_b32 v31, 0
    v_mov_b32 v32, 0
    v_mov_b32 v33, 0
    v_mov_b32 v34, 0
    v_mov_b32 v35, 0
    v_mov_b32 v36, 0
    v_mov_b32 v37, 0
    v_mov_b32 v38, 0
    v_mov_b32 v39, 0
    v_mov_b32 v40, 0
    v_mov_b32 v41, 0
    v_mov_b32 v42, 0
    v_mov_b32 v43, 0
    v_mov_b32 v44, 0
    v_mov_b32 v45, 0
    v_mov_b32 v46, 0
    v_mov_b32 v47, 0
    v_and_b32 v4, 3, v2
    v_mul_u32_u24 v5, 4176, v4
    v_cmp_eq_u32 vcc, 3, v4
    v_add_u32 v6, 8, v5
    s_nop 0
    v_cndmask_b32 v5, v5, v6, vcc
    v_lshrrev_b32 v4, 2, v2
    v_sub_u32 v4, v4, v3
    v_add_u32 v4, 3, v4
    v_lshl_add_u32 v5, v4, 4, v5
    v_add_u32 v8, s6, v5
    v_add_u32 v10, 16, v2
    s_add_u32 s47, s6, 16704
    v_bfe_u32 v4, v10, 2, 1
    v_lshlrev_b32 v4, 1, v4
    v_xor_b32 v4, v4, v3
    v_lshlrev_b32 v4, 4, v4
    v_lshl_add_u32 v4, v10, 6, v4
    v_add_u32 v9, s47, v4
    s_waitcnt vmcnt(0) lgkmcnt(0)
    ds_read_b128 v[48:51], v9 offset:0
    ds_read_b128 v[52:55], v9 offset:1024
    ds_read_b128 v[56:59], v9 offset:2048
    ds_read_b128 v[60:63], v9 offset:3072
    ds_read_b64 v[64:65], v8 offset:0
    ds_read_b64 v[66:67], v8 offset:8
    ds_read_b64 v[68:69], v8 offset:8
    ds_read_b64 v[70:71], v8 offset:16
    ds_read_b64 v[72:73], v8 offset:1024
    ds_read_b64 v[74:75], v8 offset:1032
    ds_read_b64 v[76:77], v8 offset:1032
    ds_read_b64 v[78:79], v8 offset:1040
    ds_read_b64 v[80:81], v8 offset:2048
    ds_read_b64 v[82:83], v8 offset:2056
    ds_read_b64 v[84:85], v8 offset:2056
    ds_read_b64 v[86:87], v8 offset:2064
    ds_read_b64 v[88:89], v8 offset:3072
    ds_read_b64 v[90:91], v8 offset:3080
    ds_read_b64 v[92:93], v8 offset:3080
    ds_read_b64 v[94:95], v8 offset:3088
    v_add_u32 v8, 64, v8
    v_add_u32 v10, -1, v10
    v_bfe_u32 v4, v10, 2, 1
    v_lshlrev_b32 v4, 1, v4
    v_xor_b32 v4, v4, v3
    v_lshlrev_b32 v4, 4, v4
    v_lshl_add_u32 v4, v10, 6, v4
    v_add_u32 v9, s47, v4
    s_mov_b32 s46, 0
L_convloop_18:
    s_waitcnt lgkmcnt(12)
    v_mfma_f32_16x16x32_bf16 v[16:19], v[64:67], v[48:51], v[16:19]
    ds_read_b128 v[96:99], v9 offset:0
    v_mfma_f32_16x16x32_bf16 v[32:35], v[68:71], v[48:51], v[32:35]
    ds_read_b128 v[100:103], v9 offset:1024
    v_mfma_f32_16x16x32_bf16 v[20:23], v[64:67], v[52:55], v[20:23]
    ds_read_b128 v[104:107], v9 offset:2048
    v_mfma_f32_16x16x32_bf16 v[36:39], v[68:71], v[52:55], v[36:39]
    ds_read_b128 v[108:111], v9 offset:3072
    v_mfma_f32_16x16x32_bf16 v[24:27], v[64:67], v[56:59], v[24:27]
    ds_read_b64 v[112:113], v8 offset:0
    v_mfma_f32_16x16x32_bf16 v[40:43], v[68:71], v[56:59], v[40:43]
    ds_read_b64 v[114:115], v8 offset:8
    v_mfma_f32_16x16x32_bf16 v[28:31], v[64:67], v[60:63], v[28:31]
    ds_read_b64 v[116:117], v8 offset:8
    v_mfma_f32_16x16x32_bf16 v[44:47], v[68:71], v[60:63], v[44:47]
    ds_read_b64 v[118:119], v8 offset:16
    s_waitcnt lgkmcnt(15)
    v_mfma_f32_16x16x32_bf16 v[20:23], v[72:75], v[48:51], v[20:23]
    ds_read_b64 v[120:121], v8 offset:1024
    v_mfma_f32_16x16x32_bf16 v[36:39], v[76:79], v[48:51], v[36:39]
    ds_read_b64 v[122:123], v8 offset:1032
    v_mfma_f32_16x16x32_bf16 v[24:27], v[72:75], v[52:55], v[24:27]
    ds_read_b64 v[124:125], v8 offset:1032
    v_mfma_f32_16x16x32_bf16 v[40:43], v[76:79], v[52:55], v[40:43]
    ds_read_b64 v[126:127], v8 offset:1040
    v_mfma_f32_16x16x32_bf16 v[28:31], v[72:75], v[56:59], v[28:31]
    ds_read_b64 v[128:129], v8 offset:2048
    v_mfma_f32_16x16x32_bf16 v[44:47], v[76:79], v[56:59], v[44:47]
    ds_read_b64 v[130:131], v8 offset:2056
    s_waitcnt lgkmcnt(15)
    v_mfma_f32_16x16x32_bf16 v[24:27], v[80:83], v[48:51], v[24:27]
    ds_read_b64 v[132:133], v8 offset:2056
    v_mfma_f32_16x16x32_bf16 v[40:43], v[84:87], v[48:51], v[40:43]
    ds_read_b64 v[134:135], v8 offset:2064
    v_mfma_f32_16x16x32_bf16 v[28:31], v[80:83], v[52:55], v[28:31]
    ds_read_b64 v[136:137], v8 offset:3072
    v_mfma_f32_16x16x32_bf16 v[44:47], v[84:87], v[52:55], v[44:47]
    ds_read_b64 v[138:139], v8 offset:3080
    s_waitcnt lgkmcnt(15)
    v_mfma_f32_16x16x32_bf16 v[28:31], v[88:91], v[48:51], v[28:31]
    ds_read_b64 v[140:141], v8 offset:3080
    v_mfma_f32_16x16x32_bf16 v[44:47], v[92:95], v[48:51], v[44:47]
    ds_read_b64 v[142:143], v8 offset:3088
    v_add_u32 v8, 64, v8
    v_add_u32 v10, -1, v10
    v_bfe_u32 v4, v10, 2, 1
    v_lshlrev_b32 v4, 1, v4
    v_xor_b32 v4, v4, v3
    v_lshlrev_b32 v4, 4, v4
    v_lshl_add_u32 v4, v10, 6, v4
    v_add_u32 v9, s47, v4
    s_waitcnt lgkmcnt(12)
    v_mfma_f32_16x16x32_bf16 v[16:19], v[112:115], v[96:99], v[16:19]
    ds_read_b128 v[48:51], v9 offset:0
    v_mfma_f32_16x16x32_bf16 v[32:35], v[116:119], v[96:99], v[32:35]
    ds_read_b128 v[52:55], v9 offset:1024
    v_mfma_f32_16x16x32_bf16 v[20:23], v[112:115], v[100:103], v[20:23]
    ds_read_b128 v[56:59], v9 offset:2048
    v_mfma_f32_16x16x32_bf16 v[36:39], v[116:119], v[100:103], v[36:39]
    ds_read_b128 v[60:63], v9 offset:3072
    v_mfma_f32_16x16x32_bf16 v[24:27], v[112:115], v[104:107], v[24:27]
    ds_read_b64 v[64:65], v8 offset:0
    v_mfma_f32_16x16x32_bf16 v[40:43], v[116:119], v[104:107], v[40:43]
    ds_read_b64 v[66:67], v8 offset:8
    v_mfma_f32_16x16x32_bf16 v[28:31], v[112:115], v[108:111], v[28:31]
    ds_read_b64 v[68:69], v8 offset:8
    v_mfma_f32_16x16x32_bf16 v[44:47], v[116:119], v[108:111], v[44:47]
    ds_read_b64 v[70:71], v8 offset:16
    s_waitcnt lgkmcnt(15)
    v_mfma_f32_16x16x32_bf16 v[20:23], v[120:123], v[96:99], v[20:23]
    ds_read_b64 v[72:73], v8 offset:1024
    v_mfma_f32_16x16x32_bf16 v[36:39], v[124:127], v[96:99], v[36:39]
    ds_read_b64 v[74:75], v8 offset:1032
    v_mfma_f32_16x16x32_bf16 v[24:27], v[120:123], v[100:103], v[24:27]
    ds_read_b64 v[76:77], v8 offset:1032
    v_mfma_f32_16x16x32_bf16 v[40:43], v[124:127], v[100:103], v[40:43]
    ds_read_b64 v[78:79], v8 offset:1040
    v_mfma_f32_16x16x32_bf16 v[28:31], v[120:123], v[104:107], v[28:31]
    ds_read_b64 v[80:81], v8 offset:2048
    v_mfma_f32_16x16x32_bf16 v[44:47], v[124:127], v[104:107], v[44:47]
    ds_read_b64 v[82:83], v8 offset:2056
    s_waitcnt lgkmcnt(15)
    v_mfma_f32_16x16x32_bf16 v[24:27], v[128:131], v[96:99], v[24:27]
    ds_read_b64 v[84:85], v8 offset:2056
    v_mfma_f32_16x16x32_bf16 v[40:43], v[132:135], v[96:99], v[40:43]
    ds_read_b64 v[86:87], v8 offset:2064
    v_mfma_f32_16x16x32_bf16 v[28:31], v[128:131], v[100:103], v[28:31]
    ds_read_b64 v[88:89], v8 offset:3072
    v_mfma_f32_16x16x32_bf16 v[44:47], v[132:135], v[100:103], v[44:47]
    ds_read_b64 v[90:91], v8 offset:3080
    s_waitcnt lgkmcnt(15)
    v_mfma_f32_16x16x32_bf16 v[28:31], v[136:139], v[96:99], v[28:31]
    ds_read_b64 v[92:93], v8 offset:3080
    v_mfma_f32_16x16x32_bf16 v[44:47], v[140:143], v[96:99], v[44:47]
    ds_read_b64 v[94:95], v8 offset:3088
    v_add_u32 v8, 64, v8
    v_add_u32 v10, -1, v10
    v_bfe_u32 v4, v10, 2, 1
    v_lshlrev_b32 v4, 1, v4
    v_xor_b32 v4, v4, v3
    v_lshlrev_b32 v4, 4, v4
    v_lshl_add_u32 v4, v10, 6, v4
    v_add_u32 v9, s47, v4
    s_add_u32 s46, s46, 1
    s_cmp_lt_u32 s46, 8
    s_cbranch_scc1 L_convloop_18
    s_waitcnt lgkmcnt(0)
    s_nop 7
    v_cvt_pk_bf16_f32 v48, v16, v17
    v_cvt_pk_bf16_f32 v49, v18, v19
    v_cvt_pk_bf16_f32 v50, v32, v33
    v_cvt_pk_bf16_f32 v51, v34, v35
    v_cvt_pk_bf16_f32 v52, v20, v21
    v_cvt_pk_bf16_f32 v53, v22, v23
    v_cvt_pk_bf16_f32 v54, v36, v37
    v_cvt_pk_bf16_f32 v55, v38, v39
    v_cvt_pk_bf16_f32 v56, v24, v25
    v_cvt_pk_bf16_f32 v57, v26, v27
    v_cvt_pk_bf16_f32 v58, v40, v41
    v_cvt_pk_bf16_f32 v59, v42, v43
    v_cvt_pk_bf16_f32 v60, v28, v29
    v_cvt_pk_bf16_f32 v61, v30, v31
    v_cvt_pk_bf16_f32 v62, v44, v45
    v_cvt_pk_bf16_f32 v63, v46, v47
    v_lshlrev_b32 v4, 6, v2
    v_lshl_add_u32 v4, v3, 4, v4
    s_lshl_b32 s50, s5, 12
    s_add_u32 s50, s50, 1048576
    buffer_store_dwordx4 v[48:51], v4, s[60:63], s50 offen offset:0 sc1
    buffer_store_dwordx4 v[52:55], v4, s[60:63], s50 offen offset:1024 sc1
    buffer_store_dwordx4 v[56:59], v4, s[60:63], s50 offen offset:2048 sc1
    buffer_store_dwordx4 v[60:63], v4, s[60:63], s50 offen offset:3072 sc1
    s_lshl_b32 s50, s5, 6
    s_add_u32 s43, s50, 98304
    s_cmp_lt_u32 s4, 88
    s_cbranch_scc1 L_f3now_19
    s_mov_b32 s41, 1
    s_branch L_postconv_10
L_f3now_19:
    s_waitcnt vmcnt(0)
    v_mov_b32 v5, s43
    v_mov_b32 v6, s24
    s_mov_b64 exec, 1
    global_store_dword v5, v6, s[16:17] sc1
    s_mov_b64 exec, -1
L_postconv_10:
    s_cmp_ge_u32 s4, 88
    s_cbranch_scc1 L_g2_21
    s_cmp_ge_u32 s4, 80
    s_cbranch_scc1 L_afin_20
    s_and_b32 s50, s4, 7
    s_lshr_b32 s51, s4, 3
    s_lshr_b32 s52, s50, 1
    s_lshl_b32 s52, s52, 2
    s_and_b32 s53, s51, 3
    s_add_u32 s52, s52, s53
    s_and_b32 s53, s50, 1
    s_lshl_b32 s53, s53, 3
    s_lshr_b32 s54, s51, 2
    s_add_u32 s53, s53, s54
    s_lshl_b32 s52, s52, 2
    s_add_u32 s52, s52, s3
    s_lshl_b32 s52, s52, 4
    s_add_u32 s52, s52, s53
    s_lshl_b32 s52, s52, 6
    s_add_u32 s52, s52, 163840
    v_mov_b32 v4, s52
    s_mov_b64 exec, 1
    s_mov_b32 s30, 0
L_fw_22:
    global_load_dword v5, v4, s[16:17] sc1
    s_add_u32 s30, s30, 1
    s_cmp_gt_u32 s30, 262144
    s_cbranch_scc1 L_fwx_23
    s_waitcnt vmcnt(0)
    v_cmp_ne_u32 vcc, s24, v5
    s_nop 4
    s_cbranch_vccnz L_fw_22
L_fwx_23:
    s_waitcnt vmcnt(0)
    s_mov_b64 exec, -1
    s_lshl_b32 s49, s4, 2
    s_add_u32 s49, s49, s3
    s_and_b32 s50, s49, 31
    s_lshr_b32 s51, s49, 5
    v_lshrrev_b32 v4, 3, v1
    v_and_b32 v5, 7, v1
    v_mul_u32_u24 v10, 1280, v4
    v_lshl_add_u32 v10, v5, 4, v10
    s_mul_i32 s52, s50, 81920
    s_lshl_b32 s53, s51, 7
    s_add_u32 s52, s52, s53
    v_lshlrev_b32 v6, 4, v5
    v_add_u32 v6, s53, v6
    global_load_dwordx4 v[80:83], v6, s[96:97]
    s_mov_b32 s32, s20
    s_mov_b32 s33, s21
    s_mov_b32 s34, 2621440
    s_mov_b32 s35, 0x20000
    buffer_load_dwordx4 v[16:19], v10, s[32:35], s52 offen
    s_add_u32 s52, s52, 10240
    buffer_load_dwordx4 v[20:23], v10, s[32:35], s52 offen
    s_add_u32 s52, s52, 10240
    buffer_load_dwordx4 v[24:27], v10, s[32:35], s52 offen
    s_add_u32 s52, s52, 10240
    buffer_load_dwordx4 v[28:31], v10, s[32:35], s52 offen
    s_add_u32 s52, s52, 10240
    buffer_load_dwordx4 v[32:35], v10, s[32:35], s52 offen
    s_add_u32 s52, s52, 10240
    buffer_load_dwordx4 v[36:39], v10, s[32:35], s52 offen
    s_add_u32 s52, s52, 10240
    buffer_load_dwordx4 v[40:43], v10, s[32:35], s52 offen
    s_add_u32 s52, s52, 10240
    buffer_load_dwordx4 v[44:47], v10, s[32:35], s52 offen
    v_lshlrev_b32 v4, 12, v4
    v_bfe_u32 v6, v1, 4, 1
    v_lshlrev_b32 v6, 1, v6
    v_xor_b32 v6, v6, v5
    v_lshl_add_u32 v8, v6, 4, v4
    v_xor_b32 v6, 4, v6
    v_lshl_add_u32 v9, v6, 4, v4
    s_lshl_b32 s53, s51, 12
    s_add_u32 s53, s53, 98304
    v_lshlrev_b32 v4, 6, v1
    v_add_u32 v4, s53, v4
    s_mov_b32 s30, 0
L_s3_24:
    global_load_dword v5, v4, s[16:17] sc1
    s_add_u32 s30, s30, 1
    s_cmp_gt_u32 s30, 262144
    s_cbranch_scc1 L_s3x_25
    s_waitcnt vmcnt(0)
    v_cmp_ne_u32 vcc, s24, v5
    s_nop 4
    s_cbranch_vccnz L_s3_24
L_s3x_25:
    s_waitcnt vmcnt(0)
    s_lshl_b32 s52, s51, 18
    s_lshl_b32 s53, s50, 7
    s_add_u32 s52, s52, s53
    s_add_u32 s52, s52, 1048576
    s_add_u32 m0, s6, 0
    s_nop 0
    buffer_load_dwordx4 v8, s[60:63], s52 offen sc1 lds
    s_add_u32 s52, s52, 32768
    s_add_u32 m0, s6, 1024
    s_nop 0
    buffer_load_dwordx4 v9, s[60:63], s52 offen sc1 lds
    s_add_u32 s52, s52, 32768
    s_add_u32 m0, s6, 2048
    s_nop 0
    buffer_load_dwordx4 v8, s[60:63], s52 offen sc1 lds
    s_add_u32 s52, s52, 32768
    s_add_u32 m0, s6, 3072
    s_nop 0
    buffer_load_dwordx4 v9, s[60:63], s52 offen sc1 lds
    s_add_u32 s52, s52, 32768
    s_add_u32 m0, s6, 4096
    s_nop 0
    buffer_load_dwordx4 v8, s[60:63], s52 offen sc1 lds
    s_add_u32 s52, s52, 32768
    s_add_u32 m0, s6, 5120
    s_nop 0
    buffer_load_dwordx4 v9, s[60:63], s52 offen sc1 lds
    s_add_u32 s52, s52, 32768
    s_add_u32 m0, s6, 6144
    s_nop 0
    buffer_load_dwordx4 v8, s[60:63], s52 offen sc1 lds
    s_add_u32 s52, s52, 32768
    s_add_u32 m0, s6, 7168
    s_nop 0
    buffer_load_dwordx4 v9, s[60:63], s52 offen sc1 lds
    s_add_u32 s52, s52, 32768
    v_lshrrev_b32 v4, 2, v2
    v_lshl_add_u32 v5, v3, 3, v4
    v_lshlrev_b32 v5, 7, v5
    v_add_u32 v5, s6, v5
    v_and_b32 v6, 1, v1
    v_lshl_add_u32 v5, v6, 3, v5
    v_bfe_u32 v6, v1, 1, 1
    v_lshl_add_u32 v5, v6, 4, v5
    v_and_b32 v4, 2, v4
    v_and_b32 v6, 1, v3
    v_lshl_or_b32 v4, v6, 2, v4
    v_xor_b32 v6, 0, v4
    v_lshl_add_u32 v11, v6, 4, v5
    v_xor_b32 v6, 2, v4
    v_lshl_add_u32 v12, v6, 4, v5
    v_xor_b32 v6, 4, v4
    v_lshl_add_u32 v13, v6, 4, v5
    v_xor_b32 v6, 6, v4
    v_lshl_add_u32 v14, v6, 4, v5
    v_and_b32 v4, 7, v2
    v_lshlrev_b32 v5, 7, v2
    v_add_u32 v5, s6, v5
    v_add_u32 v6, 0, v3
    v_xor_b32 v6, v6, v4
    v_lshl_add_u32 v100, v6, 4, v5
    v_add_u32 v6, 4, v3
    v_xor_b32 v6, v6, v4
    v_lshl_add_u32 v101, v6, 4, v5
    v_lshrrev_b32 v4, 3, v1
    v_and_b32 v5, 7, v1
    v_xor_b32 v5, v5, v4
    v_lshlrev_b32 v5, 4, v5
    v_lshl_add_u32 v5, v4, 7, v5
    v_add_u32 v102, s6, v5
    v_mul_u32_u24 v103, 2560, v4
    v_and_b32 v5, 7, v1
    v_lshl_add_u32 v103, v5, 4, v103
    s_mul_i32 s54, s50, 163840
    s_lshl_b32 s53, s51, 7
    s_add_u32 s54, s54, s53
    s_waitcnt vmcnt(0)
    v_lshlrev_b32 v84, 16, v80
    v_and_b32 v85, 0xffff0000, v80
    v_lshlrev_b32 v86, 16, v81
    v_and_b32 v87, 0xffff0000, v81
    v_lshlrev_b32 v88, 16, v82
    v_and_b32 v89, 0xffff0000, v82
    v_lshlrev_b32 v90, 16, v83
    v_and_b32 v91, 0xffff0000, v83
    ds_read_b64_tr_b16 v[48:49], v11 offset:0
    ds_read_b64_tr_b16 v[50:51], v11 offset:512
    ds_read_b64_tr_b16 v[52:53], v12 offset:0
    ds_read_b64_tr_b16 v[54:55], v12 offset:512
    ds_read_b64_tr_b16 v[56:57], v13 offset:0
    ds_read_b64_tr_b16 v[58:59], v13 offset:512
    ds_read_b64_tr_b16 v[60:61], v14 offset:0
    ds_read_b64_tr_b16 v[62:63], v14 offset:512
    ds_read_b64_tr_b16 v[64:65], v11 offset:4096
    ds_read_b64_tr_b16 v[66:67], v11 offset:4608
    ds_read_b64_tr_b16 v[68:69], v12 offset:4096
    ds_read_b64_tr_b16 v[70:71], v12 offset:4608
    ds_read_b64_tr_b16 v[72:73], v13 offset:4096
    ds_read_b64_tr_b16 v[74:75], v13 offset:4608
    ds_read_b64_tr_b16 v[76:77], v14 offset:4096
    ds_read_b64_tr_b16 v[78:79], v14 offset:4608
    s_waitcnt lgkmcnt(0)
    ds_write_b128 v100, v[48:51] offset:0
    ds_write_b128 v100, v[52:55] offset:2048
    ds_write_b128 v100, v[56:59] offset:4096
    ds_write_b128 v100, v[60:63] offset:6144
    ds_write_b128 v101, v[64:67] offset:0
    ds_write_b128 v101, v[68:71] offset:2048
    ds_write_b128 v101, v[72:75] offset:4096
    ds_write_b128 v101, v[76:79] offset:6144
    s_waitcnt lgkmcnt(0)
    ds_read_b128 v[48:51], v102 offset:0
    ds_read_b128 v[52:55], v102 offset:1024
    ds_read_b128 v[56:59], v102 offset:2048
    ds_read_b128 v[60:63], v102 offset:3072
    ds_read_b128 v[64:67], v102 offset:4096
    ds_read_b128 v[68:71], v102 offset:5120
    ds_read_b128 v[72:75], v102 offset:6144
    ds_read_b128 v[76:79], v102 offset:7168
    s_waitcnt lgkmcnt(7)
    v_lshlrev_b32 v92, 16, v16
    v_and_b32 v93, 0xffff0000, v16
    v_pk_mul_f32 v[92:93], v[92:93], v[84:85]
    v_lshlrev_b32 v94, 16, v48
    v_cvt_pk_bf16_f32 v16, v92, v93
    v_and_b32 v95, 0xffff0000, v48
    v_lshlrev_b32 v92, 16, v16
    v_and_b32 v93, 0xffff0000, v16
    v_pk_add_f32 v[92:93], v[92:93], v[94:95]
    v_cvt_pk_bf16_f32 v48, v92, v93
    v_lshlrev_b32 v92, 16, v17
    v_and_b32 v93, 0xffff0000, v17
    v_pk_mul_f32 v[92:93], v[92:93], v[86:87]
    v_lshlrev_b32 v94, 16, v49
    v_cvt_pk_bf16_f32 v17, v92, v93
    v_and_b32 v95, 0xffff0000, v49
    v_lshlrev_b32 v92, 16, v17
    v_and_b32 v93, 0xffff0000, v17
    v_pk_add_f32 v[92:93], v[92:93], v[94:95]
    v_cvt_pk_bf16_f32 v49, v92, v93
    v_lshlrev_b32 v92, 16, v18
    v_and_b32 v93, 0xffff0000, v18
    v_pk_mul_f32 v[92:93], v[92:93], v[88:89]
    v_lshlrev_b32 v94, 16, v50
    v_cvt_pk_bf16_f32 v18, v92, v93
    v_and_b32 v95, 0xffff0000, v50
    v_lshlrev_b32 v92, 16, v18
    v_and_b32 v93, 0xffff0000, v18
    v_pk_add_f32 v[92:93], v[92:93], v[94:95]
    v_cvt_pk_bf16_f32 v50, v92, v93
    v_lshlrev_b32 v92, 16, v19
    v_and_b32 v93, 0xffff0000, v19
    v_pk_mul_f32 v[92:93], v[92:93], v[90:91]
    v_lshlrev_b32 v94, 16, v51
    v_cvt_pk_bf16_f32 v19, v92, v93
    v_and_b32 v95, 0xffff0000, v51
    v_lshlrev_b32 v92, 16, v19
    v_and_b32 v93, 0xffff0000, v19
    v_pk_add_f32 v[92:93], v[92:93], v[94:95]
    v_cvt_pk_bf16_f32 v51, v92, v93
    buffer_store_dwordx4 v[48:51], v103, s[36:39], s54 offen sc1
    s_add_u32 s54, s54, 20480
    s_waitcnt lgkmcnt(6)
    v_lshlrev_b32 v92, 16, v20
    v_and_b32 v93, 0xffff0000, v20
    v_pk_mul_f32 v[92:93], v[92:93], v[84:85]
    v_lshlrev_b32 v94, 16, v52
    v_cvt_pk_bf16_f32 v20, v92, v93
    v_and_b32 v95, 0xffff0000, v52
    v_lshlrev_b32 v92, 16, v20
    v_and_b32 v93, 0xffff0000, v20
    v_pk_add_f32 v[92:93], v[92:93], v[94:95]
    v_cvt_pk_bf16_f32 v52, v92, v93
    v_lshlrev_b32 v92, 16, v21
    v_and_b32 v93, 0xffff0000, v21
    v_pk_mul_f32 v[92:93], v[92:93], v[86:87]
    v_lshlrev_b32 v94, 16, v53
    v_cvt_pk_bf16_f32 v21, v92, v93
    v_and_b32 v95, 0xffff0000, v53
    v_lshlrev_b32 v92, 16, v21
    v_and_b32 v93, 0xffff0000, v21
    v_pk_add_f32 v[92:93], v[92:93], v[94:95]
    v_cvt_pk_bf16_f32 v53, v92, v93
    v_lshlrev_b32 v92, 16, v22
    v_and_b32 v93, 0xffff0000, v22
    v_pk_mul_f32 v[92:93], v[92:93], v[88:89]
    v_lshlrev_b32 v94, 16, v54
    v_cvt_pk_bf16_f32 v22, v92, v93
    v_and_b32 v95, 0xffff0000, v54
    v_lshlrev_b32 v92, 16, v22
    v_and_b32 v93, 0xffff0000, v22
    v_pk_add_f32 v[92:93], v[92:93], v[94:95]
    v_cvt_pk_bf16_f32 v54, v92, v93
    v_lshlrev_b32 v92, 16, v23
    v_and_b32 v93, 0xffff0000, v23
    v_pk_mul_f32 v[92:93], v[92:93], v[90:91]
    v_lshlrev_b32 v94, 16, v55
    v_cvt_pk_bf16_f32 v23, v92, v93
    v_and_b32 v95, 0xffff0000, v55
    v_lshlrev_b32 v92, 16, v23
    v_and_b32 v93, 0xffff0000, v23
    v_pk_add_f32 v[92:93], v[92:93], v[94:95]
    v_cvt_pk_bf16_f32 v55, v92, v93
    buffer_store_dwordx4 v[52:55], v103, s[36:39], s54 offen sc1
    s_add_u32 s54, s54, 20480
    s_waitcnt lgkmcnt(5)
    v_lshlrev_b32 v92, 16, v24
    v_and_b32 v93, 0xffff0000, v24
    v_pk_mul_f32 v[92:93], v[92:93], v[84:85]
    v_lshlrev_b32 v94, 16, v56
    v_cvt_pk_bf16_f32 v24, v92, v93
    v_and_b32 v95, 0xffff0000, v56
    v_lshlrev_b32 v92, 16, v24
    v_and_b32 v93, 0xffff0000, v24
    v_pk_add_f32 v[92:93], v[92:93], v[94:95]
    v_cvt_pk_bf16_f32 v56, v92, v93
    v_lshlrev_b32 v92, 16, v25
    v_and_b32 v93, 0xffff0000, v25
    v_pk_mul_f32 v[92:93], v[92:93], v[86:87]
    v_lshlrev_b32 v94, 16, v57
    v_cvt_pk_bf16_f32 v25, v92, v93
    v_and_b32 v95, 0xffff0000, v57
    v_lshlrev_b32 v92, 16, v25
    v_and_b32 v93, 0xffff0000, v25
    v_pk_add_f32 v[92:93], v[92:93], v[94:95]
    v_cvt_pk_bf16_f32 v57, v92, v93
    v_lshlrev_b32 v92, 16, v26
    v_and_b32 v93, 0xffff0000, v26
    v_pk_mul_f32 v[92:93], v[92:93], v[88:89]
    v_lshlrev_b32 v94, 16, v58
    v_cvt_pk_bf16_f32 v26, v92, v93
    v_and_b32 v95, 0xffff0000, v58
    v_lshlrev_b32 v92, 16, v26
    v_and_b32 v93, 0xffff0000, v26
    v_pk_add_f32 v[92:93], v[92:93], v[94:95]
    v_cvt_pk_bf16_f32 v58, v92, v93
    v_lshlrev_b32 v92, 16, v27
    v_and_b32 v93, 0xffff0000, v27
    v_pk_mul_f32 v[92:93], v[92:93], v[90:91]
    v_lshlrev_b32 v94, 16, v59
    v_cvt_pk_bf16_f32 v27, v92, v93
    v_and_b32 v95, 0xffff0000, v59
    v_lshlrev_b32 v92, 16, v27
    v_and_b32 v93, 0xffff0000, v27
    v_pk_add_f32 v[92:93], v[92:93], v[94:95]
    v_cvt_pk_bf16_f32 v59, v92, v93
    buffer_store_dwordx4 v[56:59], v103, s[36:39], s54 offen sc1
    s_add_u32 s54, s54, 20480
    s_waitcnt lgkmcnt(4)
    v_lshlrev_b32 v92, 16, v28
    v_and_b32 v93, 0xffff0000, v28
    v_pk_mul_f32 v[92:93], v[92:93], v[84:85]
    v_lshlrev_b32 v94, 16, v60
    v_cvt_pk_bf16_f32 v28, v92, v93
    v_and_b32 v95, 0xffff0000, v60
    v_lshlrev_b32 v92, 16, v28
    v_and_b32 v93, 0xffff0000, v28
    v_pk_add_f32 v[92:93], v[92:93], v[94:95]
    v_cvt_pk_bf16_f32 v60, v92, v93
    v_lshlrev_b32 v92, 16, v29
    v_and_b32 v93, 0xffff0000, v29
    v_pk_mul_f32 v[92:93], v[92:93], v[86:87]
    v_lshlrev_b32 v94, 16, v61
    v_cvt_pk_bf16_f32 v29, v92, v93
    v_and_b32 v95, 0xffff0000, v61
    v_lshlrev_b32 v92, 16, v29
    v_and_b32 v93, 0xffff0000, v29
    v_pk_add_f32 v[92:93], v[92:93], v[94:95]
    v_cvt_pk_bf16_f32 v61, v92, v93
    v_lshlrev_b32 v92, 16, v30
    v_and_b32 v93, 0xffff0000, v30
    v_pk_mul_f32 v[92:93], v[92:93], v[88:89]
    v_lshlrev_b32 v94, 16, v62
    v_cvt_pk_bf16_f32 v30, v92, v93
    v_and_b32 v95, 0xffff0000, v62
    v_lshlrev_b32 v92, 16, v30
    v_and_b32 v93, 0xffff0000, v30
    v_pk_add_f32 v[92:93], v[92:93], v[94:95]
    v_cvt_pk_bf16_f32 v62, v92, v93
    v_lshlrev_b32 v92, 16, v31
    v_and_b32 v93, 0xffff0000, v31
    v_pk_mul_f32 v[92:93], v[92:93], v[90:91]
    v_lshlrev_b32 v94, 16, v63
    v_cvt_pk_bf16_f32 v31, v92, v93
    v_and_b32 v95, 0xffff0000, v63
    v_lshlrev_b32 v92, 16, v31
    v_and_b32 v93, 0xffff0000, v31
    v_pk_add_f32 v[92:93], v[92:93], v[94:95]
    v_cvt_pk_bf16_f32 v63, v92, v93
    buffer_store_dwordx4 v[60:63], v103, s[36:39], s54 offen sc1
    s_add_u32 s54, s54, 20480
    s_waitcnt lgkmcnt(3)
    v_lshlrev_b32 v92, 16, v32
    v_and_b32 v93, 0xffff0000, v32
    v_pk_mul_f32 v[92:93], v[92:93], v[84:85]
    v_lshlrev_b32 v94, 16, v64
    v_cvt_pk_bf16_f32 v32, v92, v93
    v_and_b32 v95, 0xffff0000, v64
    v_lshlrev_b32 v92, 16, v32
    v_and_b32 v93, 0xffff0000, v32
    v_pk_add_f32 v[92:93], v[92:93], v[94:95]
    v_cvt_pk_bf16_f32 v64, v92, v93
    v_lshlrev_b32 v92, 16, v33
    v_and_b32 v93, 0xffff0000, v33
    v_pk_mul_f32 v[92:93], v[92:93], v[86:87]
    v_lshlrev_b32 v94, 16, v65
    v_cvt_pk_bf16_f32 v33, v92, v93
    v_and_b32 v95, 0xffff0000, v65
    v_lshlrev_b32 v92, 16, v33
    v_and_b32 v93, 0xffff0000, v33
    v_pk_add_f32 v[92:93], v[92:93], v[94:95]
    v_cvt_pk_bf16_f32 v65, v92, v93
    v_lshlrev_b32 v92, 16, v34
    v_and_b32 v93, 0xffff0000, v34
    v_pk_mul_f32 v[92:93], v[92:93], v[88:89]
    v_lshlrev_b32 v94, 16, v66
    v_cvt_pk_bf16_f32 v34, v92, v93
    v_and_b32 v95, 0xffff0000, v66
    v_lshlrev_b32 v92, 16, v34
    v_and_b32 v93, 0xffff0000, v34
    v_pk_add_f32 v[92:93], v[92:93], v[94:95]
    v_cvt_pk_bf16_f32 v66, v92, v93
    v_lshlrev_b32 v92, 16, v35
    v_and_b32 v93, 0xffff0000, v35
    v_pk_mul_f32 v[92:93], v[92:93], v[90:91]
    v_lshlrev_b32 v94, 16, v67
    v_cvt_pk_bf16_f32 v35, v92, v93
    v_and_b32 v95, 0xffff0000, v67
    v_lshlrev_b32 v92, 16, v35
    v_and_b32 v93, 0xffff0000, v35
    v_pk_add_f32 v[92:93], v[92:93], v[94:95]
    v_cvt_pk_bf16_f32 v67, v92, v93
    buffer_store_dwordx4 v[64:67], v103, s[36:39], s54 offen sc1
    s_add_u32 s54, s54, 20480
    s_waitcnt lgkmcnt(2)
    v_lshlrev_b32 v92, 16, v36
    v_and_b32 v93, 0xffff0000, v36
    v_pk_mul_f32 v[92:93], v[92:93], v[84:85]
    v_lshlrev_b32 v94, 16, v68
    v_cvt_pk_bf16_f32 v36, v92, v93
    v_and_b32 v95, 0xffff0000, v68
    v_lshlrev_b32 v92, 16, v36
    v_and_b32 v93, 0xffff0000, v36
    v_pk_add_f32 v[92:93], v[92:93], v[94:95]
    v_cvt_pk_bf16_f32 v68, v92, v93
    v_lshlrev_b32 v92, 16, v37
    v_and_b32 v93, 0xffff0000, v37
    v_pk_mul_f32 v[92:93], v[92:93], v[86:87]
    v_lshlrev_b32 v94, 16, v69
    v_cvt_pk_bf16_f32 v37, v92, v93
    v_and_b32 v95, 0xffff0000, v69
    v_lshlrev_b32 v92, 16, v37
    v_and_b32 v93, 0xffff0000, v37
    v_pk_add_f32 v[92:93], v[92:93], v[94:95]
    v_cvt_pk_bf16_f32 v69, v92, v93
    v_lshlrev_b32 v92, 16, v38
    v_and_b32 v93, 0xffff0000, v38
    v_pk_mul_f32 v[92:93], v[92:93], v[88:89]
    v_lshlrev_b32 v94, 16, v70
    v_cvt_pk_bf16_f32 v38, v92, v93
    v_and_b32 v95, 0xffff0000, v70
    v_lshlrev_b32 v92, 16, v38
    v_and_b32 v93, 0xffff0000, v38
    v_pk_add_f32 v[92:93], v[92:93], v[94:95]
    v_cvt_pk_bf16_f32 v70, v92, v93
    v_lshlrev_b32 v92, 16, v39
    v_and_b32 v93, 0xffff0000, v39
    v_pk_mul_f32 v[92:93], v[92:93], v[90:91]
    v_lshlrev_b32 v94, 16, v71
    v_cvt_pk_bf16_f32 v39, v92, v93
    v_and_b32 v95, 0xffff0000, v71
    v_lshlrev_b32 v92, 16, v39
    v_and_b32 v93, 0xffff0000, v39
    v_pk_add_f32 v[92:93], v[92:93], v[94:95]
    v_cvt_pk_bf16_f32 v71, v92, v93
    buffer_store_dwordx4 v[68:71], v103, s[36:39], s54 offen sc1
    s_add_u32 s54, s54, 20480
    s_waitcnt lgkmcnt(1)
    v_lshlrev_b32 v92, 16, v40
    v_and_b32 v93, 0xffff0000, v40
    v_pk_mul_f32 v[92:93], v[92:93], v[84:85]
    v_lshlrev_b32 v94, 16, v72
    v_cvt_pk_bf16_f32 v40, v92, v93
    v_and_b32 v95, 0xffff0000, v72
    v_lshlrev_b32 v92, 16, v40
    v_and_b32 v93, 0xffff0000, v40
    v_pk_add_f32 v[92:93], v[92:93], v[94:95]
    v_cvt_pk_bf16_f32 v72, v92, v93
    v_lshlrev_b32 v92, 16, v41
    v_and_b32 v93, 0xffff0000, v41
    v_pk_mul_f32 v[92:93], v[92:93], v[86:87]
    v_lshlrev_b32 v94, 16, v73
    v_cvt_pk_bf16_f32 v41, v92, v93
    v_and_b32 v95, 0xffff0000, v73
    v_lshlrev_b32 v92, 16, v41
    v_and_b32 v93, 0xffff0000, v41
    v_pk_add_f32 v[92:93], v[92:93], v[94:95]
    v_cvt_pk_bf16_f32 v73, v92, v93
    v_lshlrev_b32 v92, 16, v42
    v_and_b32 v93, 0xffff0000, v42
    v_pk_mul_f32 v[92:93], v[92:93], v[88:89]
    v_lshlrev_b32 v94, 16, v74
    v_cvt_pk_bf16_f32 v42, v92, v93
    v_and_b32 v95, 0xffff0000, v74
    v_lshlrev_b32 v92, 16, v42
    v_and_b32 v93, 0xffff0000, v42
    v_pk_add_f32 v[92:93], v[92:93], v[94:95]
    v_cvt_pk_bf16_f32 v74, v92, v93
    v_lshlrev_b32 v92, 16, v43
    v_and_b32 v93, 0xffff0000, v43
    v_pk_mul_f32 v[92:93], v[92:93], v[90:91]
    v_lshlrev_b32 v94, 16, v75
    v_cvt_pk_bf16_f32 v43, v92, v93
    v_and_b32 v95, 0xffff0000, v75
    v_lshlrev_b32 v92, 16, v43
    v_and_b32 v93, 0xffff0000, v43
    v_pk_add_f32 v[92:93], v[92:93], v[94:95]
    v_cvt_pk_bf16_f32 v75, v92, v93
    buffer_store_dwordx4 v[72:75], v103, s[36:39], s54 offen sc1
    s_add_u32 s54, s54, 20480
    s_waitcnt lgkmcnt(0)
    v_lshlrev_b32 v92, 16, v44
    v_and_b32 v93, 0xffff0000, v44
    v_pk_mul_f32 v[92:93], v[92:93], v[84:85]
    v_lshlrev_b32 v94, 16, v76
    v_cvt_pk_bf16_f32 v44, v92, v93
    v_and_b32 v95, 0xffff0000, v76
    v_lshlrev_b32 v92, 16, v44
    v_and_b32 v93, 0xffff0000, v44
    v_pk_add_f32 v[92:93], v[92:93], v[94:95]
    v_cvt_pk_bf16_f32 v76, v92, v93
    v_lshlrev_b32 v92, 16, v45
    v_and_b32 v93, 0xffff0000, v45
    v_pk_mul_f32 v[92:93], v[92:93], v[86:87]
    v_lshlrev_b32 v94, 16, v77
    v_cvt_pk_bf16_f32 v45, v92, v93
    v_and_b32 v95, 0xffff0000, v77
    v_lshlrev_b32 v92, 16, v45
    v_and_b32 v93, 0xffff0000, v45
    v_pk_add_f32 v[92:93], v[92:93], v[94:95]
    v_cvt_pk_bf16_f32 v77, v92, v93
    v_lshlrev_b32 v92, 16, v46
    v_and_b32 v93, 0xffff0000, v46
    v_pk_mul_f32 v[92:93], v[92:93], v[88:89]
    v_lshlrev_b32 v94, 16, v78
    v_cvt_pk_bf16_f32 v46, v92, v93
    v_and_b32 v95, 0xffff0000, v78
    v_lshlrev_b32 v92, 16, v46
    v_and_b32 v93, 0xffff0000, v46
    v_pk_add_f32 v[92:93], v[92:93], v[94:95]
    v_cvt_pk_bf16_f32 v78, v92, v93
    v_lshlrev_b32 v92, 16, v47
    v_and_b32 v93, 0xffff0000, v47
    v_pk_mul_f32 v[92:93], v[92:93], v[90:91]
    v_lshlrev_b32 v94, 16, v79
    v_cvt_pk_bf16_f32 v47, v92, v93
    v_and_b32 v95, 0xffff0000, v79
    v_lshlrev_b32 v92, 16, v47
    v_and_b32 v93, 0xffff0000, v47
    v_pk_add_f32 v[92:93], v[92:93], v[94:95]
    v_cvt_pk_bf16_f32 v79, v92, v93
    buffer_store_dwordx4 v[76:79], v103, s[36:39], s54 offen sc1
    s_branch L_afin_20
L_g2_21:
    s_barrier
    s_sub_u32 s49, s4, 88
    s_and_b32 s50, s49, 15
    s_lshr_b32 s51, s49, 4
    s_mov_b32 s32, s26
    s_mov_b32 s33, s27
    s_mov_b32 s34, 819200
    s_mov_b32 s35, 0x20000
    v_lshrrev_b32 v4, 3, v1
    v_mul_u32_u24 v4, 1280, v4
    v_bfe_u32 v5, v1, 4, 1
    v_lshlrev_b32 v5, 1, v5
    v_and_b32 v6, 7, v1
    v_xor_b32 v5, v5, v6
    v_lshl_add_u32 v8, v5, 4, v4
    v_xor_b32 v5, 4, v5
    v_lshl_add_u32 v9, v5, 4, v4
    s_mul_i32 s52, s3, 204800
    s_lshl_b32 s53, s51, 7
    s_add_u32 s52, s52, s53
    s_mul_i32 s53, s3, 20480
    s_add_u32 m0, s53, 0
    s_nop 0
    buffer_load_dwordx4 v8, s[32:35], s52 offen lds
    s_add_u32 s52, s52, 10240
    s_add_u32 m0, s53, 1024
    s_nop 0
    buffer_load_dwordx4 v9, s[32:35], s52 offen lds
    s_add_u32 s52, s52, 10240
    s_add_u32 m0, s53, 2048
    s_nop 0
    buffer_load_dwordx4 v8, s[32:35], s52 offen lds
    s_add_u32 s52, s52, 10240
    s_add_u32 m0, s53, 3072
    s_nop 0
    buffer_load_dwordx4 v9, s[32:35], s52 offen lds
    s_add_u32 s52, s52, 10240
    s_waitcnt vmcnt(0)
    s_cmp_eq_u32 s41, 0
    s_cbranch_scc1 L_f3b_26
    v_mov_b32 v5, s43
    v_mov_b32 v6, s24
    s_mov_b64 exec, 1
    global_store_dword v5, v6, s[16:17] sc1
    s_mov_b64 exec, -1
L_f3b_26:
    s_add_u32 m0, s53, 4096
    s_nop 0
    buffer_load_dwordx4 v8, s[32:35], s52 offen lds
    s_add_u32 s52, s52, 10240
    s_add_u32 m0, s53, 5120
    s_nop 0
    buffer_load_dwordx4 v9, s[32:35], s52 offen lds
    s_add_u32 s52, s52, 10240
    s_add_u32 m0, s53, 6144
    s_nop 0
    buffer_load_dwordx4 v8, s[32:35], s52 offen lds
    s_add_u32 s52, s52, 10240
    s_add_u32 m0, s53, 7168
    s_nop 0
    buffer_load_dwordx4 v9, s[32:35], s52 offen lds
    s_add_u32 s52, s52, 10240
    s_waitcnt vmcnt(0)
    s_add_u32 m0, s53, 8192
    s_nop 0
    buffer_load_dwordx4 v8, s[32:35], s52 offen lds
    s_add_u32 s52, s52, 10240
    s_add_u32 m0, s53, 9216
    s_nop 0
    buffer_load_dwordx4 v9, s[32:35], s52 offen lds
    s_add_u32 s52, s52, 10240
    s_add_u32 m0, s53, 10240
    s_nop 0
    buffer_load_dwordx4 v8, s[32:35], s52 offen lds
    s_add_u32 s52, s52, 10240
    s_add_u32 m0, s53, 11264
    s_nop 0
    buffer_load_dwordx4 v9, s[32:35], s52 offen lds
    s_add_u32 s52, s52, 10240
    s_waitcnt vmcnt(0)
    s_add_u32 m0, s53, 12288
    s_nop 0
    buffer_load_dwordx4 v8, s[32:35], s52 offen lds
    s_add_u32 s52, s52, 10240
    s_add_u32 m0, s53, 13312
    s_nop 0
    buffer_load_dwordx4 v9, s[32:35], s52 offen lds
    s_add_u32 s52, s52, 10240
    s_add_u32 m0, s53, 14336
    s_nop 0
    buffer_load_dwordx4 v8, s[32:35], s52 offen lds
    s_add_u32 s52, s52, 10240
    s_add_u32 m0, s53, 15360
    s_nop 0
    buffer_load_dwordx4 v9, s[32:35], s52 offen lds
    s_add_u32 s52, s52, 10240
    s_waitcnt vmcnt(0)
    s_add_u32 m0, s53, 16384
    s_nop 0
    buffer_load_dwordx4 v8, s[32:35], s52 offen lds
    s_add_u32 s52, s52, 10240
    s_add_u32 m0, s53, 17408
    s_nop 0
    buffer_load_dwordx4 v9, s[32:35], s52 offen lds
    s_add_u32 s52, s52, 10240
    s_add_u32 m0, s53, 18432
    s_nop 0
    buffer_load_dwordx4 v8, s[32:35], s52 offen lds
    s_add_u32 s52, s52, 10240
    s_add_u32 m0, s53, 19456
    s_nop 0
    buffer_load_dwordx4 v9, s[32:35], s52 offen lds
    s_add_u32 s52, s52, 10240
    s_waitcnt vmcnt(0)
    v_lshrrev_b32 v4, 2, v2
    v_lshl_add_u32 v5, v3, 3, v4
    v_lshlrev_b32 v5, 7, v5
    v_and_b32 v6, 1, v1
    v_lshl_add_u32 v5, v6, 3, v5
    v_bfe_u32 v6, v1, 1, 1
    v_lshl_add_u32 v5, v6, 4, v5
    v_and_b32 v4, 2, v4
    v_and_b32 v6, 1, v3
    v_lshl_or_b32 v4, v6, 2, v4
    v_xor_b32 v6, 0, v4
    v_lshl_add_u32 v10, v6, 4, v5
    v_xor_b32 v6, 2, v4
    v_lshl_add_u32 v11, v6, 4, v5
    v_xor_b32 v6, 4, v4
    v_lshl_add_u32 v12, v6, 4, v5
    v_xor_b32 v6, 6, v4
    v_lshl_add_u32 v13, v6, 4, v5
    v_lshlrev_b32 v14, 4, v1
    s_mul_i32 s52, s50, 163840
    s_mul_i32 s53, s3, 40960
    s_add_u32 s52, s52, s53
    s_add_u32 s40, s52, 8388608
    s_lshl_b32 s52, s50, 7
    s_lshl_b32 s53, s3, 5
    s_add_u32 s52, s52, s53
    v_add_u32 v4, s52, v2
    v_mul_u32_u24 v4, 2560, v4
    v_and_b32 v5, 1, v3
    v_lshl_add_u32 v4, v5, 5, v4
    v_lshrrev_b32 v5, 1, v3
    v_lshl_add_u32 v4, v5, 4, v4
    s_lshl_b32 s53, s51, 7
    s_add_u32 s53, s53, 1280
    v_add_u32 v15, s53, v4
    v_add_u32 v16, 49152, v10
    v_add_u32 v17, 49152, v11
    v_add_u32 v18, 49152, v12
    v_add_u32 v19, 49152, v13
    s_waitcnt vmcnt(0)
    s_barrier
    s_setprio 3
    s_lshl_b32 s52, s50, 2
    s_add_u32 s52, s52, s3
    s_lshl_b32 s52, s52, 10
    s_add_u32 s52, s52, 163840
    v_lshlrev_b32 v20, 6, v2
    v_add_u32 v20, s52, v20
    s_mov_b32 s48, 0
    s_mov_b32 s30, 0
L_g2chk_27:
    s_and_b32 s49, s48, 240
    s_cmp_eq_u32 s49, 240
    s_cbranch_scc1 L_g2ok_28
    s_add_u32 s30, s30, 1
    s_cmp_gt_u32 s30, 262144
    s_cbranch_scc1 L_g2ok_28
    s_mov_b64 exec, 0xffff
    global_load_dword v5, v20, s[16:17] sc1
    s_waitcnt vmcnt(0)
    v_cmp_eq_u32 vcc, s24, v5
    s_mov_b64 exec, -1
    s_nop 3
    s_mov_b32 s48, vcc_lo
    s_branch L_g2chk_27
L_g2ok_28:
    s_add_u32 s52, s40, 4096
    buffer_load_dwordx4 v[136:139], v14, s[60:63], s52 offen offset:1024 sc1
    s_add_u32 s52, s40, 24576
    buffer_load_dwordx4 v[140:143], v14, s[60:63], s52 offen offset:1024 sc1
    s_add_u32 s52, s40, 4096
    buffer_load_dwordx4 v[144:147], v14, s[60:63], s52 offen offset:2048 sc1
    s_add_u32 s52, s40, 24576
    buffer_load_dwordx4 v[148:151], v14, s[60:63], s52 offen offset:2048 sc1
    s_add_u32 s52, s40, 4096
    buffer_load_dwordx4 v[152:155], v14, s[60:63], s52 offen offset:3072 sc1
    s_add_u32 s52, s40, 24576
    buffer_load_dwordx4 v[156:159], v14, s[60:63], s52 offen offset:3072 sc1
    s_add_u32 s52, s40, 8192
    buffer_load_dwordx4 v[160:163], v14, s[60:63], s52 offen offset:0 sc1
    s_add_u32 s52, s40, 28672
    buffer_load_dwordx4 v[164:167], v14, s[60:63], s52 offen offset:0 sc1
    s_add_u32 s52, s40, 8192
    buffer_load_dwordx4 v[168:171], v14, s[60:63], s52 offen offset:1024 sc1
    s_add_u32 s52, s40, 28672
    buffer_load_dwordx4 v[172:175], v14, s[60:63], s52 offen offset:1024 sc1
L_g2chk_29:
    s_and_b32 s49, s48, 61440
    s_cmp_eq_u32 s49, 61440
    s_cbranch_scc1 L_g2ok_30
    s_add_u32 s30, s30, 1
    s_cmp_gt_u32 s30, 262144
    s_cbranch_scc1 L_g2ok_30
    s_mov_b64 exec, 0xffff
    global_load_dword v5, v20, s[16:17] sc1
    s_waitcnt vmcnt(0)
    v_cmp_eq_u32 vcc, s24, v5
    s_mov_b64 exec, -1
    s_nop 3
    s_mov_b32 s48, vcc_lo
    s_branch L_g2chk_29
L_g2ok_30:
    s_add_u32 s52, s40, 12288
    buffer_load_dwordx4 v[216:219], v14, s[60:63], s52 offen offset:3072 sc1
    s_add_u32 s52, s40, 32768
    buffer_load_dwordx4 v[220:223], v14, s[60:63], s52 offen offset:3072 sc1
    s_add_u32 s52, s40, 16384
    buffer_load_dwordx4 v[224:227], v14, s[60:63], s52 offen offset:0 sc1
    s_add_u32 s52, s40, 36864
    buffer_load_dwordx4 v[228:231], v14, s[60:63], s52 offen offset:0 sc1
    s_add_u32 s52, s40, 16384
    buffer_load_dwordx4 v[232:235], v14, s[60:63], s52 offen offset:1024 sc1
    s_add_u32 s52, s40, 36864
    buffer_load_dwordx4 v[236:239], v14, s[60:63], s52 offen offset:1024 sc1
    s_add_u32 s52, s40, 16384
    buffer_load_dwordx4 v[240:243], v14, s[60:63], s52 offen offset:2048 sc1
    s_add_u32 s52, s40, 36864
    buffer_load_dwordx4 v[244:247], v14, s[60:63], s52 offen offset:2048 sc1
    s_add_u32 s52, s40, 16384
    buffer_load_dwordx4 v[248:251], v14, s[60:63], s52 offen offset:3072 sc1
    s_add_u32 s52, s40, 36864
    buffer_load_dwordx4 v[252:255], v14, s[60:63], s52 offen offset:3072 sc1
    s_waitcnt vmcnt(10)
    ds_read_b64_tr_b16 v[64:65], v10 offset:20480
    ds_read_b64_tr_b16 v[66:67], v10 offset:20992
    ds_read_b64_tr_b16 v[68:69], v11 offset:20480
    ds_read_b64_tr_b16 v[70:71], v11 offset:20992
    ds_read_b64_tr_b16 v[72:73], v12 offset:20480
    ds_read_b64_tr_b16 v[74:75], v12 offset:20992
    ds_read_b64_tr_b16 v[76:77], v13 offset:20480
    ds_read_b64_tr_b16 v[78:79], v13 offset:20992
    ds_read_b64_tr_b16 v[80:81], v10 offset:24576
    ds_read_b64_tr_b16 v[82:83], v10 offset:25088
    ds_read_b64_tr_b16 v[84:85], v11 offset:24576
    ds_read_b64_tr_b16 v[86:87], v11 offset:25088
    s_waitcnt lgkmcnt(10)
    v_mfma_f32_16x16x32_bf16 v[24:27], v[64:67], v[136:139], 0
    v_mfma_f32_16x16x32_bf16 v[28:31], v[64:67], v[140:143], 0
    ds_read_b64_tr_b16 v[88:89], v12 offset:24576
    ds_read_b64_tr_b16 v[90:91], v12 offset:25088
    s_waitcnt lgkmcnt(10)
    v_mfma_f32_16x16x32_bf16 v[32:35], v[68:71], v[136:139], 0
    v_mfma_f32_16x16x32_bf16 v[36:39], v[68:71], v[140:143], 0
    ds_read_b64_tr_b16 v[92:93], v13 offset:24576
    ds_read_b64_tr_b16 v[94:95], v13 offset:25088
    s_waitcnt lgkmcnt(10)
    v_mfma_f32_16x16x32_bf16 v[40:43], v[72:75], v[136:139], 0
    v_mfma_f32_16x16x32_bf16 v[44:47], v[72:75], v[140:143], 0
    ds_read_b64_tr_b16 v[64:65], v10 offset:28672
    ds_read_b64_tr_b16 v[66:67], v10 offset:29184
    s_waitcnt lgkmcnt(10)
    v_mfma_f32_16x16x32_bf16 v[48:51], v[76:79], v[136:139], 0
    v_mfma_f32_16x16x32_bf16 v[52:55], v[76:79], v[140:143], 0
    ds_read_b64_tr_b16 v[68:69], v11 offset:28672
    ds_read_b64_tr_b16 v[70:71], v11 offset:29184
    s_waitcnt lgkmcnt(10)
    v_mfma_f32_16x16x32_bf16 v[24:27], v[80:83], v[144:147], v[24:27]
    v_mfma_f32_16x16x32_bf16 v[28:31], v[80:83], v[148:151], v[28:31]
    ds_read_b64_tr_b16 v[72:73], v12 offset:28672
    ds_read_b64_tr_b16 v[74:75], v12 offset:29184
    s_waitcnt lgkmcnt(10)
    v_mfma_f32_16x16x32_bf16 v[32:35], v[84:87], v[144:147], v[32:35]
    v_mfma_f32_16x16x32_bf16 v[36:39], v[84:87], v[148:151], v[36:39]
    ds_read_b64_tr_b16 v[76:77], v13 offset:28672
    ds_read_b64_tr_b16 v[78:79], v13 offset:29184
    s_waitcnt lgkmcnt(10)
    v_mfma_f32_16x16x32_bf16 v[40:43], v[88:91], v[144:147], v[40:43]
    v_mfma_f32_16x16x32_bf16 v[44:47], v[88:91], v[148:151], v[44:47]
    ds_read_b64_tr_b16 v[80:81], v10 offset:32768
    ds_read_b64_tr_b16 v[82:83], v10 offset:33280
    s_waitcnt lgkmcnt(10)
    v_mfma_f32_16x16x32_bf16 v[48:51], v[92:95], v[144:147], v[48:51]
    v_mfma_f32_16x16x32_bf16 v[52:55], v[92:95], v[148:151], v[52:55]
    ds_read_b64_tr_b16 v[84:85], v11 offset:32768
    ds_read_b64_tr_b16 v[86:87], v11 offset:33280
    s_waitcnt lgkmcnt(10)
    v_mfma_f32_16x16x32_bf16 v[24:27], v[64:67], v[152:155], v[24:27]
    v_mfma_f32_16x16x32_bf16 v[28:31], v[64:67], v[156:159], v[28:31]
    ds_read_b64_tr_b16 v[88:89], v12 offset:32768
    ds_read_b64_tr_b16 v[90:91], v12 offset:33280
    s_waitcnt lgkmcnt(10)
    v_mfma_f32_16x16x32_bf16 v[32:35], v[68:71], v[152:155], v[32:35]
    v_mfma_f32_16x16x32_bf16 v[36:39], v[68:71], v[156:159], v[36:39]
    ds_read_b64_tr_b16 v[92:93], v13 offset:32768
    ds_read_b64_tr_b16 v[94:95], v13 offset:33280
    s_waitcnt lgkmcnt(10)
    v_mfma_f32_16x16x32_bf16 v[40:43], v[72:75], v[152:155], v[40:43]
    v_mfma_f32_16x16x32_bf16 v[44:47], v[72:75], v[156:159], v[44:47]
    ds_read_b64_tr_b16 v[64:65], v10 offset:36864
    ds_read_b64_tr_b16 v[66:67], v10 offset:37376
    s_waitcnt lgkmcnt(10)
    v_mfma_f32_16x16x32_bf16 v[48:51], v[76:79], v[152:155], v[48:51]
    v_mfma_f32_16x16x32_bf16 v[52:55], v[76:79], v[156:159], v[52:55]
    ds_read_b64_tr_b16 v[68:69], v11 offset:36864
    ds_read_b64_tr_b16 v[70:71], v11 offset:37376
    s_waitcnt lgkmcnt(10)
    v_mfma_f32_16x16x32_bf16 v[24:27], v[80:83], v[160:163], v[24:27]
    v_mfma_f32_16x16x32_bf16 v[28:31], v[80:83], v[164:167], v[28:31]
    ds_read_b64_tr_b16 v[72:73], v12 offset:36864
    ds_read_b64_tr_b16 v[74:75], v12 offset:37376
    s_waitcnt lgkmcnt(10)
    v_mfma_f32_16x16x32_bf16 v[32:35], v[84:87], v[160:163], v[32:35]
    v_mfma_f32_16x16x32_bf16 v[36:39], v[84:87], v[164:167], v[36:39]
    ds_read_b64_tr_b16 v[76:77], v13 offset:36864
    ds_read_b64_tr_b16 v[78:79], v13 offset:37376
    s_waitcnt lgkmcnt(10)
    v_mfma_f32_16x16x32_bf16 v[40:43], v[88:91], v[160:163], v[40:43]
    v_mfma_f32_16x16x32_bf16 v[44:47], v[88:91], v[164:167], v[44:47]
    s_waitcnt lgkmcnt(8)
    v_mfma_f32_16x16x32_bf16 v[48:51], v[92:95], v[160:163], v[48:51]
    v_mfma_f32_16x16x32_bf16 v[52:55], v[92:95], v[164:167], v[52:55]
    s_waitcnt lgkmcnt(6)
    v_mfma_f32_16x16x32_bf16 v[24:27], v[64:67], v[168:171], v[24:27]
    v_mfma_f32_16x16x32_bf16 v[28:31], v[64:67], v[172:175], v[28:31]
    s_waitcnt lgkmcnt(4)
    v_mfma_f32_16x16x32_bf16 v[32:35], v[68:71], v[168:171], v[32:35]
    v_mfma_f32_16x16x32_bf16 v[36:39], v[68:71], v[172:175], v[36:39]
    s_waitcnt lgkmcnt(2)
    v_mfma_f32_16x16x32_bf16 v[40:43], v[72:75], v[168:171], v[40:43]
    v_mfma_f32_16x16x32_bf16 v[44:47], v[72:75], v[172:175], v[44:47]
    s_waitcnt lgkmcnt(0)
    v_mfma_f32_16x16x32_bf16 v[48:51], v[76:79], v[168:171], v[48:51]
    v_mfma_f32_16x16x32_bf16 v[52:55], v[76:79], v[172:175], v[52:55]
L_g2chk_31:
    s_and_b32 s49, s48, 15
    s_cmp_eq_u32 s49, 15
    s_cbranch_scc1 L_g2ok_32
    s_add_u32 s30, s30, 1
    s_cmp_gt_u32 s30, 262144
    s_cbranch_scc1 L_g2ok_32
    s_mov_b64 exec, 0xffff
    global_load_dword v5, v20, s[16:17] sc1
    s_waitcnt vmcnt(0)
    v_cmp_eq_u32 vcc, s24, v5
    s_mov_b64 exec, -1
    s_nop 3
    s_mov_b32 s48, vcc_lo
    s_branch L_g2chk_31
L_g2ok_32:
    s_add_u32 s52, s40, 0
    buffer_load_dwordx4 v[96:99], v14, s[60:63], s52 offen offset:0 sc1
    s_add_u32 s52, s40, 20480
    buffer_load_dwordx4 v[100:103], v14, s[60:63], s52 offen offset:0 sc1
    s_add_u32 s52, s40, 0
    buffer_load_dwordx4 v[104:107], v14, s[60:63], s52 offen offset:1024 sc1
    s_add_u32 s52, s40, 20480
    buffer_load_dwordx4 v[108:111], v14, s[60:63], s52 offen offset:1024 sc1
    s_add_u32 s52, s40, 0
    buffer_load_dwordx4 v[112:115], v14, s[60:63], s52 offen offset:2048 sc1
    s_add_u32 s52, s40, 20480
    buffer_load_dwordx4 v[116:119], v14, s[60:63], s52 offen offset:2048 sc1
    s_add_u32 s52, s40, 0
    buffer_load_dwordx4 v[120:123], v14, s[60:63], s52 offen offset:3072 sc1
    s_add_u32 s52, s40, 20480
    buffer_load_dwordx4 v[124:127], v14, s[60:63], s52 offen offset:3072 sc1
    s_add_u32 s52, s40, 4096
    buffer_load_dwordx4 v[128:131], v14, s[60:63], s52 offen offset:0 sc1
    s_add_u32 s52, s40, 24576
    buffer_load_dwordx4 v[132:135], v14, s[60:63], s52 offen offset:0 sc1
    s_waitcnt vmcnt(10)
    ds_read_b64_tr_b16 v[64:65], v16 offset:12288
    ds_read_b64_tr_b16 v[66:67], v16 offset:12800
    ds_read_b64_tr_b16 v[68:69], v17 offset:12288
    ds_read_b64_tr_b16 v[70:71], v17 offset:12800
    ds_read_b64_tr_b16 v[72:73], v18 offset:12288
    ds_read_b64_tr_b16 v[74:75], v18 offset:12800
    ds_read_b64_tr_b16 v[76:77], v19 offset:12288
    ds_read_b64_tr_b16 v[78:79], v19 offset:12800
    ds_read_b64_tr_b16 v[80:81], v16 offset:16384
    ds_read_b64_tr_b16 v[82:83], v16 offset:16896
    ds_read_b64_tr_b16 v[84:85], v17 offset:16384
    ds_read_b64_tr_b16 v[86:87], v17 offset:16896
    s_waitcnt lgkmcnt(10)
    v_mfma_f32_16x16x32_bf16 v[24:27], v[64:67], v[216:219], v[24:27]
    v_mfma_f32_16x16x32_bf16 v[28:31], v[64:67], v[220:223], v[28:31]
    ds_read_b64_tr_b16 v[88:89], v18 offset:16384
    ds_read_b64_tr_b16 v[90:91], v18 offset:16896
    s_waitcnt lgkmcnt(10)
    v_mfma_f32_16x16x32_bf16 v[32:35], v[68:71], v[216:219], v[32:35]
    v_mfma_f32_16x16x32_bf16 v[36:39], v[68:71], v[220:223], v[36:39]
    ds_read_b64_tr_b16 v[92:93], v19 offset:16384
    ds_read_b64_tr_b16 v[94:95], v19 offset:16896
    s_waitcnt lgkmcnt(10)
    v_mfma_f32_16x16x32_bf16 v[40:43], v[72:75], v[216:219], v[40:43]
    v_mfma_f32_16x16x32_bf16 v[44:47], v[72:75], v[220:223], v[44:47]
    ds_read_b64_tr_b16 v[64:65], v16 offset:20480
    ds_read_b64_tr_b16 v[66:67], v16 offset:20992
    s_waitcnt lgkmcnt(10)
    v_mfma_f32_16x16x32_bf16 v[48:51], v[76:79], v[216:219], v[48:51]
    v_mfma_f32_16x16x32_bf16 v[52:55], v[76:79], v[220:223], v[52:55]
    ds_read_b64_tr_b16 v[68:69], v17 offset:20480
    ds_read_b64_tr_b16 v[70:71], v17 offset:20992
    s_waitcnt lgkmcnt(10)
    v_mfma_f32_16x16x32_bf16 v[24:27], v[80:83], v[224:227], v[24:27]
    v_mfma_f32_16x16x32_bf16 v[28:31], v[80:83], v[228:231], v[28:31]
    ds_read_b64_tr_b16 v[72:73], v18 offset:20480
    ds_read_b64_tr_b16 v[74:75], v18 offset:20992
    s_waitcnt lgkmcnt(10)
    v_mfma_f32_16x16x32_bf16 v[32:35], v[84:87], v[224:227], v[32:35]
    v_mfma_f32_16x16x32_bf16 v[36:39], v[84:87], v[228:231], v[36:39]
    ds_read_b64_tr_b16 v[76:77], v19 offset:20480
    ds_read_b64_tr_b16 v[78:79], v19 offset:20992
    s_waitcnt lgkmcnt(10)
    v_mfma_f32_16x16x32_bf16 v[40:43], v[88:91], v[224:227], v[40:43]
    v_mfma_f32_16x16x32_bf16 v[44:47], v[88:91], v[228:231], v[44:47]
    ds_read_b64_tr_b16 v[80:81], v16 offset:24576
    ds_read_b64_tr_b16 v[82:83], v16 offset:25088
    s_waitcnt lgkmcnt(10)
    v_mfma_f32_16x16x32_bf16 v[48:51], v[92:95], v[224:227], v[48:51]
    v_mfma_f32_16x16x32_bf16 v[52:55], v[92:95], v[228:231], v[52:55]
    ds_read_b64_tr_b16 v[84:85], v17 offset:24576
    ds_read_b64_tr_b16 v[86:87], v17 offset:25088
    s_waitcnt lgkmcnt(10)
    v_mfma_f32_16x16x32_bf16 v[24:27], v[64:67], v[232:235], v[24:27]
    v_mfma_f32_16x16x32_bf16 v[28:31], v[64:67], v[236:239], v[28:31]
    ds_read_b64_tr_b16 v[88:89], v18 offset:24576
    ds_read_b64_tr_b16 v[90:91], v18 offset:25088
    s_waitcnt lgkmcnt(10)
    v_mfma_f32_16x16x32_bf16 v[32:35], v[68:71], v[232:235], v[32:35]
    v_mfma_f32_16x16x32_bf16 v[36:39], v[68:71], v[236:239], v[36:39]
    ds_read_b64_tr_b16 v[92:93], v19 offset:24576
    ds_read_b64_tr_b16 v[94:95], v19 offset:25088
    s_waitcnt lgkmcnt(10)
    v_mfma_f32_16x16x32_bf16 v[40:43], v[72:75], v[232:235], v[40:43]
    v_mfma_f32_16x16x32_bf16 v[44:47], v[72:75], v[236:239], v[44:47]
    ds_read_b64_tr_b16 v[64:65], v16 offset:28672
    ds_read_b64_tr_b16 v[66:67], v16 offset:29184
    s_waitcnt lgkmcnt(10)
    v_mfma_f32_16x16x32_bf16 v[48:51], v[76:79], v[232:235], v[48:51]
    v_mfma_f32_16x16x32_bf16 v[52:55], v[76:79], v[236:239], v[52:55]
    ds_read_b64_tr_b16 v[68:69], v17 offset:28672
    ds_read_b64_tr_b16 v[70:71], v17 offset:29184
    s_waitcnt lgkmcnt(10)
    v_mfma_f32_16x16x32_bf16 v[24:27], v[80:83], v[240:243], v[24:27]
    v_mfma_f32_16x16x32_bf16 v[28:31], v[80:83], v[244:247], v[28:31]
    ds_read_b64_tr_b16 v[72:73], v18 offset:28672
    ds_read_b64_tr_b16 v[74:75], v18 offset:29184
    s_waitcnt lgkmcnt(10)
    v_mfma_f32_16x16x32_bf16 v[32:35], v[84:87], v[240:243], v[32:35]
    v_mfma_f32_16x16x32_bf16 v[36:39], v[84:87], v[244:247], v[36:39]
    ds_read_b64_tr_b16 v[76:77], v19 offset:28672
    ds_read_b64_tr_b16 v[78:79], v19 offset:29184
    s_waitcnt lgkmcnt(10)
    v_mfma_f32_16x16x32_bf16 v[40:43], v[88:91], v[240:243], v[40:43]
    v_mfma_f32_16x16x32_bf16 v[44:47], v[88:91], v[244:247], v[44:47]
    s_waitcnt lgkmcnt(8)
    v_mfma_f32_16x16x32_bf16 v[48:51], v[92:95], v[240:243], v[48:51]
    v_mfma_f32_16x16x32_bf16 v[52:55], v[92:95], v[244:247], v[52:55]
    s_waitcnt lgkmcnt(6)
    v_mfma_f32_16x16x32_bf16 v[24:27], v[64:67], v[248:251], v[24:27]
    v_mfma_f32_16x16x32_bf16 v[28:31], v[64:67], v[252:255], v[28:31]
    s_waitcnt lgkmcnt(4)
    v_mfma_f32_16x16x32_bf16 v[32:35], v[68:71], v[248:251], v[32:35]
    v_mfma_f32_16x16x32_bf16 v[36:39], v[68:71], v[252:255], v[36:39]
    s_waitcnt lgkmcnt(2)
    v_mfma_f32_16x16x32_bf16 v[40:43], v[72:75], v[248:251], v[40:43]
    v_mfma_f32_16x16x32_bf16 v[44:47], v[72:75], v[252:255], v[44:47]
    s_waitcnt lgkmcnt(0)
    v_mfma_f32_16x16x32_bf16 v[48:51], v[76:79], v[248:251], v[48:51]
    v_mfma_f32_16x16x32_bf16 v[52:55], v[76:79], v[252:255], v[52:55]
L_g2chk_33:
    s_and_b32 s49, s48, 3840
    s_cmp_eq_u32 s49, 3840
    s_cbranch_scc1 L_g2ok_34
    s_add_u32 s30, s30, 1
    s_cmp_gt_u32 s30, 262144
    s_cbranch_scc1 L_g2ok_34
    s_mov_b64 exec, 0xffff
    global_load_dword v5, v20, s[16:17] sc1
    s_waitcnt vmcnt(0)
    v_cmp_eq_u32 vcc, s24, v5
    s_mov_b64 exec, -1
    s_nop 3
    s_mov_b32 s48, vcc_lo
    s_branch L_g2chk_33
L_g2ok_34:
    s_add_u32 s52, s40, 8192
    buffer_load_dwordx4 v[176:179], v14, s[60:63], s52 offen offset:2048 sc1
    s_add_u32 s52, s40, 28672
    buffer_load_dwordx4 v[180:183], v14, s[60:63], s52 offen offset:2048 sc1
    s_add_u32 s52, s40, 8192
    buffer_load_dwordx4 v[184:187], v14, s[60:63], s52 offen offset:3072 sc1
    s_add_u32 s52, s40, 28672
    buffer_load_dwordx4 v[188:191], v14, s[60:63], s52 offen offset:3072 sc1
    s_add_u32 s52, s40, 12288
    buffer_load_dwordx4 v[192:195], v14, s[60:63], s52 offen offset:0 sc1
    s_add_u32 s52, s40, 32768
    buffer_load_dwordx4 v[196:199], v14, s[60:63], s52 offen offset:0 sc1
    s_add_u32 s52, s40, 12288
    buffer_load_dwordx4 v[200:203], v14, s[60:63], s52 offen offset:1024 sc1
    s_add_u32 s52, s40, 32768
    buffer_load_dwordx4 v[204:207], v14, s[60:63], s52 offen offset:1024 sc1
    s_add_u32 s52, s40, 12288
    buffer_load_dwordx4 v[208:211], v14, s[60:63], s52 offen offset:2048 sc1
    s_add_u32 s52, s40, 32768
    buffer_load_dwordx4 v[212:215], v14, s[60:63], s52 offen offset:2048 sc1
    s_waitcnt vmcnt(10)
    ds_read_b64_tr_b16 v[64:65], v10 offset:0
    ds_read_b64_tr_b16 v[66:67], v10 offset:512
    ds_read_b64_tr_b16 v[68:69], v11 offset:0
    ds_read_b64_tr_b16 v[70:71], v11 offset:512
    ds_read_b64_tr_b16 v[72:73], v12 offset:0
    ds_read_b64_tr_b16 v[74:75], v12 offset:512
    ds_read_b64_tr_b16 v[76:77], v13 offset:0
    ds_read_b64_tr_b16 v[78:79], v13 offset:512
    ds_read_b64_tr_b16 v[80:81], v10 offset:4096
    ds_read_b64_tr_b16 v[82:83], v10 offset:4608
    ds_read_b64_tr_b16 v[84:85], v11 offset:4096
    ds_read_b64_tr_b16 v[86:87], v11 offset:4608
    s_waitcnt lgkmcnt(10)
    v_mfma_f32_16x16x32_bf16 v[24:27], v[64:67], v[96:99], v[24:27]
    v_mfma_f32_16x16x32_bf16 v[28:31], v[64:67], v[100:103], v[28:31]
    ds_read_b64_tr_b16 v[88:89], v12 offset:4096
    ds_read_b64_tr_b16 v[90:91], v12 offset:4608
    s_waitcnt lgkmcnt(10)
    v_mfma_f32_16x16x32_bf16 v[32:35], v[68:71], v[96:99], v[32:35]
    v_mfma_f32_16x16x32_bf16 v[36:39], v[68:71], v[100:103], v[36:39]
    ds_read_b64_tr_b16 v[92:93], v13 offset:4096
    ds_read_b64_tr_b16 v[94:95], v13 offset:4608
    s_waitcnt lgkmcnt(10)
    v_mfma_f32_16x16x32_bf16 v[40:43], v[72:75], v[96:99], v[40:43]
    v_mfma_f32_16x16x32_bf16 v[44:47], v[72:75], v[100:103], v[44:47]
    ds_read_b64_tr_b16 v[64:65], v10 offset:8192
    ds_read_b64_tr_b16 v[66:67], v10 offset:8704
    s_waitcnt lgkmcnt(10)
    v_mfma_f32_16x16x32_bf16 v[48:51], v[76:79], v[96:99], v[48:51]
    v_mfma_f32_16x16x32_bf16 v[52:55], v[76:79], v[100:103], v[52:55]
    ds_read_b64_tr_b16 v[68:69], v11 offset:8192
    ds_read_b64_tr_b16 v[70:71], v11 offset:8704
    s_waitcnt lgkmcnt(10)
    v_mfma_f32_16x16x32_bf16 v[24:27], v[80:83], v[104:107], v[24:27]
    v_mfma_f32_16x16x32_bf16 v[28:31], v[80:83], v[108:111], v[28:31]
    ds_read_b64_tr_b16 v[72:73], v12 offset:8192
    ds_read_b64_tr_b16 v[74:75], v12 offset:8704
    s_waitcnt lgkmcnt(10)
    v_mfma_f32_16x16x32_bf16 v[32:35], v[84:87], v[104:107], v[32:35]
    v_mfma_f32_16x16x32_bf16 v[36:39], v[84:87], v[108:111], v[36:39]
    ds_read_b64_tr_b16 v[76:77], v13 offset:8192
    ds_read_b64_tr_b16 v[78:79], v13 offset:8704
    s_waitcnt lgkmcnt(10)
    v_mfma_f32_16x16x32_bf16 v[40:43], v[88:91], v[104:107], v[40:43]
    v_mfma_f32_16x16x32_bf16 v[44:47], v[88:91], v[108:111], v[44:47]
    ds_read_b64_tr_b16 v[80:81], v10 offset:12288
    ds_read_b64_tr_b16 v[82:83], v10 offset:12800
    s_waitcnt lgkmcnt(10)
    v_mfma_f32_16x16x32_bf16 v[48:51], v[92:95], v[104:107], v[48:51]
    v_mfma_f32_16x16x32_bf16 v[52:55], v[92:95], v[108:111], v[52:55]
    ds_read_b64_tr_b16 v[84:85], v11 offset:12288
    ds_read_b64_tr_b16 v[86:87], v11 offset:12800
    s_waitcnt lgkmcnt(10)
    v_mfma_f32_16x16x32_bf16 v[24:27], v[64:67], v[112:115], v[24:27]
    v_mfma_f32_16x16x32_bf16 v[28:31], v[64:67], v[116:119], v[28:31]
    ds_read_b64_tr_b16 v[88:89], v12 offset:12288
    ds_read_b64_tr_b16 v[90:91], v12 offset:12800
    s_waitcnt lgkmcnt(10)
    v_mfma_f32_16x16x32_bf16 v[32:35], v[68:71], v[112:115], v[32:35]
    v_mfma_f32_16x16x32_bf16 v[36:39], v[68:71], v[116:119], v[36:39]
    ds_read_b64_tr_b16 v[92:93], v13 offset:12288
    ds_read_b64_tr_b16 v[94:95], v13 offset:12800
    s_waitcnt lgkmcnt(10)
    v_mfma_f32_16x16x32_bf16 v[40:43], v[72:75], v[112:115], v[40:43]
    v_mfma_f32_16x16x32_bf16 v[44:47], v[72:75], v[116:119], v[44:47]
    ds_read_b64_tr_b16 v[64:65], v10 offset:16384
    ds_read_b64_tr_b16 v[66:67], v10 offset:16896
    s_waitcnt lgkmcnt(10)
    v_mfma_f32_16x16x32_bf16 v[48:51], v[76:79], v[112:115], v[48:51]
    v_mfma_f32_16x16x32_bf16 v[52:55], v[76:79], v[116:119], v[52:55]
    ds_read_b64_tr_b16 v[68:69], v11 offset:16384
    ds_read_b64_tr_b16 v[70:71], v11 offset:16896
    s_waitcnt lgkmcnt(10)
    v_mfma_f32_16x16x32_bf16 v[24:27], v[80:83], v[120:123], v[24:27]
    v_mfma_f32_16x16x32_bf16 v[28:31], v[80:83], v[124:127], v[28:31]
    ds_read_b64_tr_b16 v[72:73], v12 offset:16384
    ds_read_b64_tr_b16 v[74:75], v12 offset:16896
    s_waitcnt lgkmcnt(10)
    v_mfma_f32_16x16x32_bf16 v[32:35], v[84:87], v[120:123], v[32:35]
    v_mfma_f32_16x16x32_bf16 v[36:39], v[84:87], v[124:127], v[36:39]
    ds_read_b64_tr_b16 v[76:77], v13 offset:16384
    ds_read_b64_tr_b16 v[78:79], v13 offset:16896
    s_waitcnt lgkmcnt(10)
    v_mfma_f32_16x16x32_bf16 v[40:43], v[88:91], v[120:123], v[40:43]
    v_mfma_f32_16x16x32_bf16 v[44:47], v[88:91], v[124:127], v[44:47]
    s_waitcnt lgkmcnt(8)
    v_mfma_f32_16x16x32_bf16 v[48:51], v[92:95], v[120:123], v[48:51]
    v_mfma_f32_16x16x32_bf16 v[52:55], v[92:95], v[124:127], v[52:55]
    s_waitcnt lgkmcnt(6)
    v_mfma_f32_16x16x32_bf16 v[24:27], v[64:67], v[128:131], v[24:27]
    v_mfma_f32_16x16x32_bf16 v[28:31], v[64:67], v[132:135], v[28:31]
    s_waitcnt lgkmcnt(4)
    v_mfma_f32_16x16x32_bf16 v[32:35], v[68:71], v[128:131], v[32:35]
    v_mfma_f32_16x16x32_bf16 v[36:39], v[68:71], v[132:135], v[36:39]
    s_waitcnt lgkmcnt(2)
    v_mfma_f32_16x16x32_bf16 v[40:43], v[72:75], v[128:131], v[40:43]
    v_mfma_f32_16x16x32_bf16 v[44:47], v[72:75], v[132:135], v[44:47]
    s_waitcnt lgkmcnt(0)
    v_mfma_f32_16x16x32_bf16 v[48:51], v[76:79], v[128:131], v[48:51]
    v_mfma_f32_16x16x32_bf16 v[52:55], v[76:79], v[132:135], v[52:55]
    s_waitcnt vmcnt(0)
    ds_read_b64_tr_b16 v[64:65], v10 offset:40960
    ds_read_b64_tr_b16 v[66:67], v10 offset:41472
    ds_read_b64_tr_b16 v[68:69], v11 offset:40960
    ds_read_b64_tr_b16 v[70:71], v11 offset:41472
    ds_read_b64_tr_b16 v[72:73], v12 offset:40960
    ds_read_b64_tr_b16 v[74:75], v12 offset:41472
    ds_read_b64_tr_b16 v[76:77], v13 offset:40960
    ds_read_b64_tr_b16 v[78:79], v13 offset:41472
    ds_read_b64_tr_b16 v[80:81], v10 offset:45056
    ds_read_b64_tr_b16 v[82:83], v10 offset:45568
    ds_read_b64_tr_b16 v[84:85], v11 offset:45056
    ds_read_b64_tr_b16 v[86:87], v11 offset:45568
    s_waitcnt lgkmcnt(10)
    v_mfma_f32_16x16x32_bf16 v[24:27], v[64:67], v[176:179], v[24:27]
    v_mfma_f32_16x16x32_bf16 v[28:31], v[64:67], v[180:183], v[28:31]
    ds_read_b64_tr_b16 v[88:89], v12 offset:45056
    ds_read_b64_tr_b16 v[90:91], v12 offset:45568
    s_waitcnt lgkmcnt(10)
    v_mfma_f32_16x16x32_bf16 v[32:35], v[68:71], v[176:179], v[32:35]
    v_mfma_f32_16x16x32_bf16 v[36:39], v[68:71], v[180:183], v[36:39]
    ds_read_b64_tr_b16 v[92:93], v13 offset:45056
    ds_read_b64_tr_b16 v[94:95], v13 offset:45568
    s_waitcnt lgkmcnt(10)
    v_mfma_f32_16x16x32_bf16 v[40:43], v[72:75], v[176:179], v[40:43]
    v_mfma_f32_16x16x32_bf16 v[44:47], v[72:75], v[180:183], v[44:47]
    ds_read_b64_tr_b16 v[64:65], v16 offset:0
    ds_read_b64_tr_b16 v[66:67], v16 offset:512
    s_waitcnt lgkmcnt(10)
    v_mfma_f32_16x16x32_bf16 v[48:51], v[76:79], v[176:179], v[48:51]
    v_mfma_f32_16x16x32_bf16 v[52:55], v[76:79], v[180:183], v[52:55]
    ds_read_b64_tr_b16 v[68:69], v17 offset:0
    ds_read_b64_tr_b16 v[70:71], v17 offset:512
    s_waitcnt lgkmcnt(10)
    v_mfma_f32_16x16x32_bf16 v[24:27], v[80:83], v[184:187], v[24:27]
    v_mfma_f32_16x16x32_bf16 v[28:31], v[80:83], v[188:191], v[28:31]
    ds_read_b64_tr_b16 v[72:73], v18 offset:0
    ds_read_b64_tr_b16 v[74:75], v18 offset:512
    s_waitcnt lgkmcnt(10)
    v_mfma_f32_16x16x32_bf16 v[32:35], v[84:87], v[184:187], v[32:35]
    v_mfma_f32_16x16x32_bf16 v[36:39], v[84:87], v[188:191], v[36:39]
    ds_read_b64_tr_b16 v[76:77], v19 offset:0
    ds_read_b64_tr_b16 v[78:79], v19 offset:512
    s_waitcnt lgkmcnt(10)
    v_mfma_f32_16x16x32_bf16 v[40:43], v[88:91], v[184:187], v[40:43]
    v_mfma_f32_16x16x32_bf16 v[44:47], v[88:91], v[188:191], v[44:47]
    ds_read_b64_tr_b16 v[80:81], v16 offset:4096
    ds_read_b64_tr_b16 v[82:83], v16 offset:4608
    s_waitcnt lgkmcnt(10)
    v_mfma_f32_16x16x32_bf16 v[48:51], v[92:95], v[184:187], v[48:51]
    v_mfma_f32_16x16x32_bf16 v[52:55], v[92:95], v[188:191], v[52:55]
    ds_read_b64_tr_b16 v[84:85], v17 offset:4096
    ds_read_b64_tr_b16 v[86:87], v17 offset:4608
    s_waitcnt lgkmcnt(10)
    v_mfma_f32_16x16x32_bf16 v[24:27], v[64:67], v[192:195], v[24:27]
    v_mfma_f32_16x16x32_bf16 v[28:31], v[64:67], v[196:199], v[28:31]
    ds_read_b64_tr_b16 v[88:89], v18 offset:4096
    ds_read_b64_tr_b16 v[90:91], v18 offset:4608
    s_waitcnt lgkmcnt(10)
    v_mfma_f32_16x16x32_bf16 v[32:35], v[68:71], v[192:195], v[32:35]
    v_mfma_f32_16x16x32_bf16 v[36:39], v[68:71], v[196:199], v[36:39]
    ds_read_b64_tr_b16 v[92:93], v19 offset:4096
    ds_read_b64_tr_b16 v[94:95], v19 offset:4608
    s_waitcnt lgkmcnt(10)
    v_mfma_f32_16x16x32_bf16 v[40:43], v[72:75], v[192:195], v[40:43]
    v_mfma_f32_16x16x32_bf16 v[44:47], v[72:75], v[196:199], v[44:47]
    ds_read_b64_tr_b16 v[64:65], v16 offset:8192
    ds_read_b64_tr_b16 v[66:67], v16 offset:8704
    s_waitcnt lgkmcnt(10)
    v_mfma_f32_16x16x32_bf16 v[48:51], v[76:79], v[192:195], v[48:51]
    v_mfma_f32_16x16x32_bf16 v[52:55], v[76:79], v[196:199], v[52:55]
    ds_read_b64_tr_b16 v[68:69], v17 offset:8192
    ds_read_b64_tr_b16 v[70:71], v17 offset:8704
    s_waitcnt lgkmcnt(10)
    v_mfma_f32_16x16x32_bf16 v[24:27], v[80:83], v[200:203], v[24:27]
    v_mfma_f32_16x16x32_bf16 v[28:31], v[80:83], v[204:207], v[28:31]
    ds_read_b64_tr_b16 v[72:73], v18 offset:8192
    ds_read_b64_tr_b16 v[74:75], v18 offset:8704
    s_waitcnt lgkmcnt(10)
    v_mfma_f32_16x16x32_bf16 v[32:35], v[84:87], v[200:203], v[32:35]
    v_mfma_f32_16x16x32_bf16 v[36:39], v[84:87], v[204:207], v[36:39]
    ds_read_b64_tr_b16 v[76:77], v19 offset:8192
    ds_read_b64_tr_b16 v[78:79], v19 offset:8704
    s_waitcnt lgkmcnt(10)
    v_mfma_f32_16x16x32_bf16 v[40:43], v[88:91], v[200:203], v[40:43]
    v_mfma_f32_16x16x32_bf16 v[44:47], v[88:91], v[204:207], v[44:47]
    s_waitcnt lgkmcnt(8)
    v_mfma_f32_16x16x32_bf16 v[48:51], v[92:95], v[200:203], v[48:51]
    v_mfma_f32_16x16x32_bf16 v[52:55], v[92:95], v[204:207], v[52:55]
    s_waitcnt lgkmcnt(6)
    v_mfma_f32_16x16x32_bf16 v[24:27], v[64:67], v[208:211], v[24:27]
    v_mfma_f32_16x16x32_bf16 v[28:31], v[64:67], v[212:215], v[28:31]
    s_waitcnt lgkmcnt(4)
    v_mfma_f32_16x16x32_bf16 v[32:35], v[68:71], v[208:211], v[32:35]
    v_mfma_f32_16x16x32_bf16 v[36:39], v[68:71], v[212:215], v[36:39]
    s_waitcnt lgkmcnt(2)
    v_mfma_f32_16x16x32_bf16 v[40:43], v[72:75], v[208:211], v[40:43]
    v_mfma_f32_16x16x32_bf16 v[44:47], v[72:75], v[212:215], v[44:47]
    s_waitcnt lgkmcnt(0)
    v_mfma_f32_16x16x32_bf16 v[48:51], v[76:79], v[208:211], v[48:51]
    v_mfma_f32_16x16x32_bf16 v[52:55], v[76:79], v[212:215], v[52:55]
    s_nop 7
    v_cvt_pk_bf16_f32 v64, v24, v25
    v_cvt_pk_bf16_f32 v65, v26, v27
    v_cvt_pk_bf16_f32 v66, v32, v33
    v_cvt_pk_bf16_f32 v67, v34, v35
    s_nop 0
    v_permlane16_swap_b32 v64, v66
    v_permlane16_swap_b32 v65, v67
    s_mov_b32 s52, 0
    buffer_store_dwordx4 v[64:67], v15, s[36:39], s52 offen offset:0 sc1
    v_cvt_pk_bf16_f32 v68, v40, v41
    v_cvt_pk_bf16_f32 v69, v42, v43
    v_cvt_pk_bf16_f32 v70, v48, v49
    v_cvt_pk_bf16_f32 v71, v50, v51
    s_nop 0
    v_permlane16_swap_b32 v68, v70
    v_permlane16_swap_b32 v69, v71
    s_mov_b32 s52, 0
    buffer_store_dwordx4 v[68:71], v15, s[36:39], s52 offen offset:64 sc1
    v_cvt_pk_bf16_f32 v72, v28, v29
    v_cvt_pk_bf16_f32 v73, v30, v31
    v_cvt_pk_bf16_f32 v74, v36, v37
    v_cvt_pk_bf16_f32 v75, v38, v39
    s_nop 0
    v_permlane16_swap_b32 v72, v74
    v_permlane16_swap_b32 v73, v75
    s_mov_b32 s52, 40960
    buffer_store_dwordx4 v[72:75], v15, s[36:39], s52 offen offset:0 sc1
    v_cvt_pk_bf16_f32 v76, v44, v45
    v_cvt_pk_bf16_f32 v77, v46, v47
    v_cvt_pk_bf16_f32 v78, v52, v53
    v_cvt_pk_bf16_f32 v79, v54, v55
    s_nop 0
    v_permlane16_swap_b32 v76, v78
    v_permlane16_swap_b32 v77, v79
    s_mov_b32 s52, 40960
    buffer_store_dwordx4 v[76:79], v15, s[36:39], s52 offen offset:64 sc1
L_afin_20:
L_end:
    s_endpgm
.section .rodata,"a"
.p2align 6
.amdhsa_kernel concat_heads__ssm_conv_s4d__linear_kernel_hedgehog__prompt_kernel
  .amdhsa_next_free_vgpr 256
  .amdhsa_next_free_sgpr 102
  .amdhsa_accum_offset 256
  .amdhsa_group_segment_fixed_size 0
  .amdhsa_kernarg_size 112
  .amdhsa_user_sgpr_count 2
  .amdhsa_user_sgpr_kernarg_segment_ptr 1
  .amdhsa_system_sgpr_workgroup_id_x 1
.end_amdhsa_kernel
```
